```python
import torch

def _softmax(x, axis=-1):
    return torch.softmax(x, dim=axis)
def _gelu(x):
    return torch.nn.functional.gelu(x, approximate="tanh")
def _silu(x):
    return torch.nn.functional.silu(x)
def _sigmoid(x):
    return torch.sigmoid(x)
def _layernorm(x, axis=-1, eps=1e-5):
    m = x.mean(dim=axis, keepdim=True)
    v = x.var(dim=axis, keepdim=True, unbiased=False)
    return (x - m) / torch.sqrt(v + eps)
def _scatter_add(tgt, idx, src, axis=0):
    return tgt.clone().index_add_(axis, idx, src)
def _segment_sum(src, seg, n):
    out = torch.zeros((n,) + src.shape[1:], dtype=src.dtype)
    return out.index_add_(0, seg, src)
def _pad(x, pw):
    flat = tuple(v for pair in reversed(pw) for v in pair)
    return torch.nn.functional.pad(x, flat)

kernel_name = 'sequential_preLN__gqa_block_cached__glu_gated_bilinear__decode'

def setup_inputs():

    _w = (lambda a: (lambda t: t.to(torch.bfloat16) if t.is_floating_point() else t)(torch.as_tensor(a)))
    def _A_setup():
        B, Sq, D = 1, 1, 512
        Hq, Hkv, Sk, Dh = 32, 32, 32768, 128
        assert Hq % Hkv == 0, (Hq, Hkv)
        return {
            "x": _w((lambda *s: torch.randn(*s, dtype=torch.bfloat16) * 0.05)(B, Sq, D)),
            "k_cache": _w((lambda *s: torch.randn(*s, dtype=torch.bfloat16) * 3.2)(B, Hkv, Sk, Dh)),
            "v_cache": _w((lambda *s: torch.randn(*s, dtype=torch.bfloat16) * 1.6)(B, Hkv, Sk, Dh)),
            "wq": _w((lambda *s: torch.randn(*s, dtype=torch.bfloat16) * 3.2)(D, Hq * Dh) * (D ** -0.5)),
            "wo": _w((lambda *s: torch.randn(*s, dtype=torch.bfloat16) * 1.6)(Hq * Dh, D) * ((Hq * Dh) ** -0.5)),
        }
    _A_in = _A_setup()

    def _B_setup():
        B, S, D, F = 1, 1, 512, 1376
        return {
            "x": _w((lambda *s: torch.randn(*s, dtype=torch.bfloat16) * 0.05)(B, S, D)),
            "w_gate": _w((lambda *s: torch.randn(*s, dtype=torch.bfloat16) * 1.6)(D, F) * (D ** -0.5)),
            "w_up": _w((lambda *s: torch.randn(*s, dtype=torch.bfloat16) * 1.6)(D, F) * (D ** -0.5)),
            "w_down": _w((lambda *s: torch.randn(*s, dtype=torch.bfloat16) * 1.6)(F, D) * (F ** -0.5)),
        }
    _B_in = _B_setup()

    return {
        "A_x": _A_in["x"],
        "A_k_cache": _A_in["k_cache"],
        "A_v_cache": _A_in["v_cache"],
        "A_wq": _A_in["wq"],
        "A_wo": _A_in["wo"],
        "B_x": _B_in["x"],
        "B_w_gate": _B_in["w_gate"],
        "B_w_up": _B_in["w_up"],
        "B_w_down": _B_in["w_down"],
    }

def reference(A_x, A_k_cache, A_v_cache, A_wq, A_wo, B_x, B_w_gate, B_w_up, B_w_down):
    def _A_ref(x, k_cache, v_cache, wq, wo):
        B, Sq, D = x.shape
        Hq, Dh = 32, 128
        Hkv = k_cache.shape[1]
        rep = Hq // Hkv
        q = (lambda x, *d: x.permute(*d))((x @ wq).reshape(B, Sq, Hq, Dh), 0, 2, 1, 3)
        k = (lambda x, n, axis: torch.repeat_interleave(x, n, dim=axis))(k_cache, rep, axis=1)
        v = (lambda x, n, axis: torch.repeat_interleave(x, n, dim=axis))(v_cache, rep, axis=1)
        scores = torch.einsum("bhqd,bhkd->bhqk", q, k) * (Dh ** -0.5)
        p = _softmax(scores, axis=-1)
        o = torch.einsum("bhqk,bhkd->bhqd", p, v)
        return (lambda x, *d: x.permute(*d))(o, 0, 2, 1, 3).reshape(B, Sq, Hq * Dh) @ wo

    def _B_ref(x, w_gate, w_up, w_down):
        g = torch.einsum("bsd,df->bsf", x, w_gate)
        u = torch.einsum("bsd,df->bsf", x, w_up)
        h = g * u
        return torch.einsum("bsf,fd->bsd", h, w_down)

    x = A_x
    h = x + _A_ref(_layernorm(x, axis=-1), A_k_cache, A_v_cache, A_wq, A_wo)
    h2 = h + _B_ref(_layernorm(h, axis=-1), B_w_gate, B_w_up, B_w_down)
    return h2
```

```asm
; @launch grid=(256,1,1) block=(576,1,1) lds=156672
.amdgcn_target "amdgcn-amd-amdhsa--gfx950"
.text
.globl sequential_preLN__gqa_block_cached__glu_gated_bilinear__decode_kernel
.p2align 8
.type sequential_preLN__gqa_block_cached__glu_gated_bilinear__decode_kernel,@function
sequential_preLN__gqa_block_cached__glu_gated_bilinear__decode_kernel:
KSTART:
    s_cmp_ge_u32 s2, 256
    s_cbranch_scc1 L_done
    s_load_dwordx8 s[56:63], s[0:1], 0
    s_load_dwordx8 s[64:71], s[0:1], 32
    s_load_dwordx8 s[72:79], s[0:1], 64
    v_lshrrev_b32 v2, 6, v0
    v_and_b32 v0, 63, v0
    v_readfirstlane_b32 s3, v2
    s_and_b32 s4, s2, 7
    s_lshr_b32 s5, s2, 3
    v_mov_b32 v42, 0
    s_cmp_eq_u32 s3, 8
    s_cbranch_scc1 L_helper
    v_lshlrev_b32 v1, 4, v0
    s_getpc_b64 s[24:25]
L_pc0:
    s_sub_u32 s24, s24, L_pc0-KSTART
    s_subb_u32 s25, s25, 0
    s_mov_b32 s26, KEND-KSTART
    s_mov_b32 s27, 0x20000
    s_lshl_b32 s44, s3, 11
    buffer_load_dwordx4 v[112:115], v1, s[24:27], s44 offen
    buffer_load_dwordx4 v[116:119], v1, s[24:27], s44 offen offset:1024
    s_lshl_b32 s44, s5, 23
    s_mul_i32 s47, s4, 128
    s_add_u32 s45, s47, s3
    s_lshl_b32 s20, s45, 13
    s_add_u32 s21, s20, 4096
    s_add_u32 s22, s20, 65536
    s_add_u32 s28, s20, 131072
    s_add_u32 s29, s28, 4096
    s_lshl_b32 s45, s3, 14
    s_add_u32 s45, s45, 25600
    s_waitcnt lgkmcnt(0)
    s_add_u32 s8, s58, s44
    s_addc_u32 s9, s59, 0
    s_mov_b32 s10, 0x800000
    s_mov_b32 s11, 0x20000
    s_add_u32 s12, s60, s44
    s_addc_u32 s13, s61, 0
    s_mov_b32 s14, 0x800000
    s_mov_b32 s15, 0x20000
    buffer_load_dwordx4 v[48:51], v1, s[8:11], s20 offen offset:0 nt
    buffer_load_dwordx4 v[52:55], v1, s[8:11], s20 offen offset:1024 nt
    buffer_load_dwordx4 v[56:59], v1, s[8:11], s20 offen offset:2048 nt
    buffer_load_dwordx4 v[60:63], v1, s[8:11], s20 offen offset:3072 nt
    s_waitcnt vmcnt(3)
    buffer_load_dwordx4 v[64:67], v1, s[8:11], s21 offen offset:0 nt
    s_waitcnt vmcnt(3)
    buffer_load_dwordx4 v[68:71], v1, s[8:11], s21 offen offset:1024 nt
    s_waitcnt vmcnt(3)
    buffer_load_dwordx4 v[72:75], v1, s[8:11], s21 offen offset:2048 nt
    s_waitcnt vmcnt(3)
    buffer_load_dwordx4 v[76:79], v1, s[8:11], s21 offen offset:3072 nt
    s_waitcnt vmcnt(3)
    buffer_load_dwordx4 v[80:83], v1, s[12:15], s20 offen offset:0 nt
    s_waitcnt vmcnt(3)
    buffer_load_dwordx4 v[84:87], v1, s[12:15], s20 offen offset:1024 nt
    s_waitcnt vmcnt(3)
    buffer_load_dwordx4 v[88:91], v1, s[12:15], s20 offen offset:2048 nt
    s_waitcnt vmcnt(3)
    buffer_load_dwordx4 v[92:95], v1, s[12:15], s20 offen offset:3072 nt
    s_waitcnt vmcnt(3)
    buffer_load_dwordx4 v[96:99], v1, s[12:15], s21 offen offset:0 nt
    s_waitcnt vmcnt(3)
    buffer_load_dwordx4 v[100:103], v1, s[12:15], s21 offen offset:1024 nt
    s_waitcnt vmcnt(3)
    buffer_load_dwordx4 v[104:107], v1, s[12:15], s21 offen offset:2048 nt
    s_waitcnt vmcnt(3)
    buffer_load_dwordx4 v[108:111], v1, s[12:15], s21 offen offset:3072 nt
    s_waitcnt vmcnt(3)
    s_add_u32 m0, s45, 0
    s_add_u32 s32, s22, 0
    buffer_load_dwordx4 v1, s[8:11], s32 offen nt lds
    s_waitcnt vmcnt(3)
    s_add_u32 m0, s45, 1024
    s_add_u32 s32, s22, 1024
    buffer_load_dwordx4 v1, s[8:11], s32 offen nt lds
    s_waitcnt vmcnt(3)
    s_add_u32 m0, s45, 2048
    s_add_u32 s32, s22, 2048
    buffer_load_dwordx4 v1, s[8:11], s32 offen nt lds
    s_waitcnt vmcnt(3)
    s_add_u32 m0, s45, 3072
    s_add_u32 s32, s22, 3072
    buffer_load_dwordx4 v1, s[8:11], s32 offen nt lds
    s_waitcnt vmcnt(3)
    s_add_u32 m0, s45, 4096
    s_add_u32 s32, s22, 4096
    buffer_load_dwordx4 v1, s[8:11], s32 offen nt lds
    s_waitcnt vmcnt(3)
    s_add_u32 m0, s45, 5120
    s_add_u32 s32, s22, 5120
    buffer_load_dwordx4 v1, s[8:11], s32 offen nt lds
    s_waitcnt vmcnt(3)
    s_add_u32 m0, s45, 6144
    s_add_u32 s32, s22, 6144
    buffer_load_dwordx4 v1, s[8:11], s32 offen nt lds
    s_waitcnt vmcnt(3)
    s_add_u32 m0, s45, 7168
    s_add_u32 s32, s22, 7168
    buffer_load_dwordx4 v1, s[8:11], s32 offen nt lds
    s_waitcnt vmcnt(3)
    s_add_u32 m0, s45, 8192
    s_add_u32 s32, s22, 0
    buffer_load_dwordx4 v1, s[12:15], s32 offen nt lds
    s_waitcnt vmcnt(3)
    s_add_u32 m0, s45, 9216
    s_add_u32 s32, s22, 1024
    buffer_load_dwordx4 v1, s[12:15], s32 offen nt lds
    s_waitcnt vmcnt(3)
    s_add_u32 m0, s45, 10240
    s_add_u32 s32, s22, 2048
    buffer_load_dwordx4 v1, s[12:15], s32 offen nt lds
    s_waitcnt vmcnt(3)
    s_add_u32 m0, s45, 11264
    s_add_u32 s32, s22, 3072
    buffer_load_dwordx4 v1, s[12:15], s32 offen nt lds
    s_waitcnt vmcnt(3)
    s_add_u32 m0, s45, 12288
    s_add_u32 s32, s22, 4096
    buffer_load_dwordx4 v1, s[12:15], s32 offen nt lds
    s_waitcnt vmcnt(3)
    s_add_u32 m0, s45, 13312
    s_add_u32 s32, s22, 5120
    buffer_load_dwordx4 v1, s[12:15], s32 offen nt lds
    s_waitcnt vmcnt(3)
    s_add_u32 m0, s45, 14336
    s_add_u32 s32, s22, 6144
    buffer_load_dwordx4 v1, s[12:15], s32 offen nt lds
    s_waitcnt vmcnt(3)
    s_add_u32 m0, s45, 15360
    s_add_u32 s32, s22, 7168
    buffer_load_dwordx4 v1, s[12:15], s32 offen nt lds
    v_add_u32 v43, s45, v1
    s_load_dword s80, s[78:79], 0
    s_mov_b32 s16, s78
    s_mov_b32 s17, s79
    s_mov_b32 s18, 0x40000000
    s_mov_b32 s19, 0x20000
    s_mov_b32 s30, 0xcccccccc
    s_mov_b32 s31, 0xcccccccc
    v_and_b32 v2, 15, v0
    v_and_b32 v36, 1, v2
    v_lshlrev_b32 v36, 4, v36
    v_mov_b32 v37, 0xffff
    v_lshlrev_b32 v37, v36, v37
    v_lshrrev_b32 v36, 1, v2
    v_cmp_eq_u32 vcc, 0, v36
    s_nop 1
    v_cndmask_b32 v8, 0, v37, vcc
    v_cmp_eq_u32 vcc, 1, v36
    s_nop 1
    v_cndmask_b32 v9, 0, v37, vcc
    v_cmp_eq_u32 vcc, 2, v36
    s_nop 1
    v_cndmask_b32 v10, 0, v37, vcc
    v_cmp_eq_u32 vcc, 3, v36
    s_nop 1
    v_cndmask_b32 v11, 0, v37, vcc
    v_mov_b32 v20, 0
    v_mov_b32 v21, 0
    v_mov_b32 v22, 0
    v_mov_b32 v23, 0
    v_mov_b32 v33, 0
    v_mov_b32 v35, 0xff800000
    v_lshlrev_b32 v2, 4, v2
    s_waitcnt lgkmcnt(0)
    s_add_u32 s80, s80, 0x9e3779b9
    s_and_b32 s44, s5, 3
    s_and_b32 s45, s4, 3
    s_lshr_b32 s50, s5, 2
    s_mov_b32 s51, 1
    s_cmp_eq_u32 s44, s45
    s_cbranch_scc1 L_rolek
    s_cmp_gt_u32 s44, s45
    s_cselect_b32 s45, 1, 0
    s_sub_u32 s44, s44, s45
    s_mul_i32 s50, s50, 3
    s_add_u32 s44, s44, s50
    s_mov_b32 s51, 3
    s_mov_b32 s50, s44
    s_cmp_eq_u32 s4, 2
    s_cselect_b32 s45, 16, 0
    s_cmp_lt_u32 s44, s45
    s_cbranch_scc1 L_rolek
    s_mul_i32 s50, s4, 22
    s_add_u32 s50, s50, s44
    s_mov_b32 s51, 2
    s_cmp_lt_u32 s4, 2
    s_cselect_b32 s45, 43, 0
    s_cmp_lt_u32 s44, 22
    s_cselect_b32 s45, s45, 0
    s_cmp_lt_u32 s50, s45
    s_cbranch_scc1 L_rolek
    s_mov_b32 s51, 0
L_rolek:
    s_barrier
    ds_read_b128 v[4:7], v2 offset:256
    s_waitcnt lgkmcnt(0)
    s_waitcnt vmcnt(31)
    v_dot2_f32_bf16 v24, v48, v4, 0
    v_dot2_f32_bf16 v24, v49, v5, v24
    v_dot2_f32_bf16 v24, v50, v6, v24
    v_dot2_f32_bf16 v24, v51, v7, v24
    buffer_load_dwordx4 v[48:51], v1, s[8:11], s28 offen offset:0 nt
    s_waitcnt vmcnt(31)
    v_dot2_f32_bf16 v25, v52, v4, 0
    v_dot2_f32_bf16 v25, v53, v5, v25
    v_dot2_f32_bf16 v25, v54, v6, v25
    v_dot2_f32_bf16 v25, v55, v7, v25
    buffer_load_dwordx4 v[52:55], v1, s[8:11], s28 offen offset:1024 nt
    s_waitcnt vmcnt(31)
    v_dot2_f32_bf16 v26, v56, v4, 0
    v_dot2_f32_bf16 v26, v57, v5, v26
    v_dot2_f32_bf16 v26, v58, v6, v26
    v_dot2_f32_bf16 v26, v59, v7, v26
    buffer_load_dwordx4 v[56:59], v1, s[8:11], s28 offen offset:2048 nt
    s_waitcnt vmcnt(31)
    v_dot2_f32_bf16 v27, v60, v4, 0
    v_dot2_f32_bf16 v27, v61, v5, v27
    v_dot2_f32_bf16 v27, v62, v6, v27
    v_dot2_f32_bf16 v27, v63, v7, v27
    buffer_load_dwordx4 v[60:63], v1, s[8:11], s28 offen offset:3072 nt
    s_waitcnt vmcnt(31)
    v_dot2_f32_bf16 v28, v64, v4, 0
    v_dot2_f32_bf16 v28, v65, v5, v28
    v_dot2_f32_bf16 v28, v66, v6, v28
    v_dot2_f32_bf16 v28, v67, v7, v28
    buffer_load_dwordx4 v[64:67], v1, s[8:11], s29 offen offset:0 nt
    s_waitcnt vmcnt(31)
    v_dot2_f32_bf16 v29, v68, v4, 0
    v_dot2_f32_bf16 v29, v69, v5, v29
    v_dot2_f32_bf16 v29, v70, v6, v29
    v_dot2_f32_bf16 v29, v71, v7, v29
    buffer_load_dwordx4 v[68:71], v1, s[8:11], s29 offen offset:1024 nt
    s_waitcnt vmcnt(31)
    v_dot2_f32_bf16 v30, v72, v4, 0
    v_dot2_f32_bf16 v30, v73, v5, v30
    v_dot2_f32_bf16 v30, v74, v6, v30
    v_dot2_f32_bf16 v30, v75, v7, v30
    buffer_load_dwordx4 v[72:75], v1, s[8:11], s29 offen offset:2048 nt
    s_waitcnt vmcnt(31)
    v_dot2_f32_bf16 v31, v76, v4, 0
    v_dot2_f32_bf16 v31, v77, v5, v31
    v_dot2_f32_bf16 v31, v78, v6, v31
    v_dot2_f32_bf16 v31, v79, v7, v31
    buffer_load_dwordx4 v[76:79], v1, s[8:11], s29 offen offset:3072 nt
    s_nop 2
    v_add_f32_dpp v24, v24, v24 row_mirror row_mask:0xf bank_mask:0x3
    v_add_f32_dpp v25, v25, v25 row_mirror row_mask:0xf bank_mask:0x3
    v_add_f32_dpp v26, v26, v26 row_mirror row_mask:0xf bank_mask:0x3
    v_add_f32_dpp v27, v27, v27 row_mirror row_mask:0xf bank_mask:0x3
    v_add_f32_dpp v24, v28, v28 row_mirror row_mask:0xf bank_mask:0xc
    v_add_f32_dpp v25, v29, v29 row_mirror row_mask:0xf bank_mask:0xc
    v_add_f32_dpp v26, v30, v30 row_mirror row_mask:0xf bank_mask:0xc
    v_add_f32_dpp v27, v31, v31 row_mirror row_mask:0xf bank_mask:0xc
    s_nop 0
    v_add_f32_dpp v24, v24, v24 row_half_mirror row_mask:0xf bank_mask:0x5
    v_add_f32_dpp v25, v25, v25 row_half_mirror row_mask:0xf bank_mask:0x5
    s_nop 0
    v_add_f32_dpp v24, v26, v26 row_half_mirror row_mask:0xf bank_mask:0xa
    v_add_f32_dpp v25, v27, v27 row_half_mirror row_mask:0xf bank_mask:0xa
    s_nop 1
    v_add_f32_dpp v26, v24, v24 quad_perm:[2,3,0,1] row_mask:0xf bank_mask:0xf
    v_add_f32_dpp v27, v25, v25 quad_perm:[2,3,0,1] row_mask:0xf bank_mask:0xf
    s_nop 0
    v_cndmask_b32 v26, v26, v27, s[30:31]
    s_nop 1
    v_add_f32_dpp v26, v26, v26 quad_perm:[1,0,3,2] row_mask:0xf bank_mask:0xf
    v_cvt_pk_bf16_f32 v36, v26, v26
    v_and_b32 v36, 0xffff0000, v36
    v_mul_f32 v36, 0x3db504f3, v36
    v_cvt_pk_bf16_f32 v36, v36, v36
    v_and_b32 v26, 0xffff0000, v36
    v_cmp_gt_f32 vcc, v26, v35
    s_nop 1
    s_cbranch_vccnz L_upd_1
L_back_2:
    v_sub_f32 v36, v26, v35
    v_mul_f32 v36, 0x3fb8aa3b, v36
    v_exp_f32 v36, v36
    s_nop 0
    v_add_f32 v33, v33, v36
    v_cvt_pk_bf16_f32 v32, v36, v36
    s_nop 1
    v_and_b32_dpp v12, v32, v8 row_newbcast:0 row_mask:0xf bank_mask:0xf
    v_and_b32_dpp v13, v32, v9 row_newbcast:0 row_mask:0xf bank_mask:0xf
    v_and_b32_dpp v14, v32, v10 row_newbcast:0 row_mask:0xf bank_mask:0xf
    v_and_b32_dpp v15, v32, v11 row_newbcast:0 row_mask:0xf bank_mask:0xf
    s_waitcnt vmcnt(31)
    s_nop 0
    v_mfma_f32_16x16x32_bf16 v[20:23], v[12:15], v[80:83], v[20:23]
    buffer_load_dwordx4 v[80:83], v1, s[12:15], s28 offen offset:0 nt
    v_and_b32_dpp v16, v32, v8 row_newbcast:2 row_mask:0xf bank_mask:0xf
    v_and_b32_dpp v17, v32, v9 row_newbcast:2 row_mask:0xf bank_mask:0xf
    v_and_b32_dpp v18, v32, v10 row_newbcast:2 row_mask:0xf bank_mask:0xf
    v_and_b32_dpp v19, v32, v11 row_newbcast:2 row_mask:0xf bank_mask:0xf
    s_waitcnt vmcnt(31)
    s_nop 0
    v_mfma_f32_16x16x32_bf16 v[20:23], v[16:19], v[84:87], v[20:23]
    buffer_load_dwordx4 v[84:87], v1, s[12:15], s28 offen offset:1024 nt
    v_and_b32_dpp v12, v32, v8 row_newbcast:4 row_mask:0xf bank_mask:0xf
    v_and_b32_dpp v13, v32, v9 row_newbcast:4 row_mask:0xf bank_mask:0xf
    v_and_b32_dpp v14, v32, v10 row_newbcast:4 row_mask:0xf bank_mask:0xf
    v_and_b32_dpp v15, v32, v11 row_newbcast:4 row_mask:0xf bank_mask:0xf
    s_waitcnt vmcnt(31)
    s_nop 0
    v_mfma_f32_16x16x32_bf16 v[20:23], v[12:15], v[88:91], v[20:23]
    buffer_load_dwordx4 v[88:91], v1, s[12:15], s28 offen offset:2048 nt
    v_and_b32_dpp v16, v32, v8 row_newbcast:6 row_mask:0xf bank_mask:0xf
    v_and_b32_dpp v17, v32, v9 row_newbcast:6 row_mask:0xf bank_mask:0xf
    v_and_b32_dpp v18, v32, v10 row_newbcast:6 row_mask:0xf bank_mask:0xf
    v_and_b32_dpp v19, v32, v11 row_newbcast:6 row_mask:0xf bank_mask:0xf
    s_waitcnt vmcnt(31)
    s_nop 0
    v_mfma_f32_16x16x32_bf16 v[20:23], v[16:19], v[92:95], v[20:23]
    buffer_load_dwordx4 v[92:95], v1, s[12:15], s28 offen offset:3072 nt
    v_and_b32_dpp v12, v32, v8 row_newbcast:8 row_mask:0xf bank_mask:0xf
    v_and_b32_dpp v13, v32, v9 row_newbcast:8 row_mask:0xf bank_mask:0xf
    v_and_b32_dpp v14, v32, v10 row_newbcast:8 row_mask:0xf bank_mask:0xf
    v_and_b32_dpp v15, v32, v11 row_newbcast:8 row_mask:0xf bank_mask:0xf
    s_waitcnt vmcnt(31)
    s_nop 0
    v_mfma_f32_16x16x32_bf16 v[20:23], v[12:15], v[96:99], v[20:23]
    buffer_load_dwordx4 v[96:99], v1, s[12:15], s29 offen offset:0 nt
    v_and_b32_dpp v16, v32, v8 row_newbcast:10 row_mask:0xf bank_mask:0xf
    v_and_b32_dpp v17, v32, v9 row_newbcast:10 row_mask:0xf bank_mask:0xf
    v_and_b32_dpp v18, v32, v10 row_newbcast:10 row_mask:0xf bank_mask:0xf
    v_and_b32_dpp v19, v32, v11 row_newbcast:10 row_mask:0xf bank_mask:0xf
    s_waitcnt vmcnt(31)
    s_nop 0
    v_mfma_f32_16x16x32_bf16 v[20:23], v[16:19], v[100:103], v[20:23]
    buffer_load_dwordx4 v[100:103], v1, s[12:15], s29 offen offset:1024 nt
    v_and_b32_dpp v12, v32, v8 row_newbcast:12 row_mask:0xf bank_mask:0xf
    v_and_b32_dpp v13, v32, v9 row_newbcast:12 row_mask:0xf bank_mask:0xf
    v_and_b32_dpp v14, v32, v10 row_newbcast:12 row_mask:0xf bank_mask:0xf
    v_and_b32_dpp v15, v32, v11 row_newbcast:12 row_mask:0xf bank_mask:0xf
    s_waitcnt vmcnt(31)
    s_nop 0
    v_mfma_f32_16x16x32_bf16 v[20:23], v[12:15], v[104:107], v[20:23]
    buffer_load_dwordx4 v[104:107], v1, s[12:15], s29 offen offset:2048 nt
    v_and_b32_dpp v16, v32, v8 row_newbcast:14 row_mask:0xf bank_mask:0xf
    v_and_b32_dpp v17, v32, v9 row_newbcast:14 row_mask:0xf bank_mask:0xf
    v_and_b32_dpp v18, v32, v10 row_newbcast:14 row_mask:0xf bank_mask:0xf
    v_and_b32_dpp v19, v32, v11 row_newbcast:14 row_mask:0xf bank_mask:0xf
    s_waitcnt vmcnt(31)
    s_nop 0
    v_mfma_f32_16x16x32_bf16 v[20:23], v[16:19], v[108:111], v[20:23]
    buffer_load_dwordx4 v[108:111], v1, s[12:15], s29 offen offset:3072 nt
    s_waitcnt vmcnt(31)
    ds_read_b128 v[112:115], v43 offset:0
    s_waitcnt lgkmcnt(0)
    v_dot2_f32_bf16 v24, v112, v4, 0
    v_dot2_f32_bf16 v24, v113, v5, v24
    v_dot2_f32_bf16 v24, v114, v6, v24
    v_dot2_f32_bf16 v24, v115, v7, v24
    s_waitcnt vmcnt(30)
    ds_read_b128 v[116:119], v43 offset:1024
    s_waitcnt lgkmcnt(0)
    v_dot2_f32_bf16 v25, v116, v4, 0
    v_dot2_f32_bf16 v25, v117, v5, v25
    v_dot2_f32_bf16 v25, v118, v6, v25
    v_dot2_f32_bf16 v25, v119, v7, v25
    s_waitcnt vmcnt(29)
    ds_read_b128 v[112:115], v43 offset:2048
    s_waitcnt lgkmcnt(0)
    v_dot2_f32_bf16 v26, v112, v4, 0
    v_dot2_f32_bf16 v26, v113, v5, v26
    v_dot2_f32_bf16 v26, v114, v6, v26
    v_dot2_f32_bf16 v26, v115, v7, v26
    s_waitcnt vmcnt(28)
    ds_read_b128 v[116:119], v43 offset:3072
    s_waitcnt lgkmcnt(0)
    v_dot2_f32_bf16 v27, v116, v4, 0
    v_dot2_f32_bf16 v27, v117, v5, v27
    v_dot2_f32_bf16 v27, v118, v6, v27
    v_dot2_f32_bf16 v27, v119, v7, v27
    s_waitcnt vmcnt(27)
    ds_read_b128 v[112:115], v43 offset:4096
    s_waitcnt lgkmcnt(0)
    v_dot2_f32_bf16 v28, v112, v4, 0
    v_dot2_f32_bf16 v28, v113, v5, v28
    v_dot2_f32_bf16 v28, v114, v6, v28
    v_dot2_f32_bf16 v28, v115, v7, v28
    s_waitcnt vmcnt(26)
    ds_read_b128 v[116:119], v43 offset:5120
    s_waitcnt lgkmcnt(0)
    v_dot2_f32_bf16 v29, v116, v4, 0
    v_dot2_f32_bf16 v29, v117, v5, v29
    v_dot2_f32_bf16 v29, v118, v6, v29
    v_dot2_f32_bf16 v29, v119, v7, v29
    s_waitcnt vmcnt(25)
    ds_read_b128 v[112:115], v43 offset:6144
    s_waitcnt lgkmcnt(0)
    v_dot2_f32_bf16 v30, v112, v4, 0
    v_dot2_f32_bf16 v30, v113, v5, v30
    v_dot2_f32_bf16 v30, v114, v6, v30
    v_dot2_f32_bf16 v30, v115, v7, v30
    s_waitcnt vmcnt(24)
    ds_read_b128 v[116:119], v43 offset:7168
    s_waitcnt lgkmcnt(0)
    v_dot2_f32_bf16 v31, v116, v4, 0
    v_dot2_f32_bf16 v31, v117, v5, v31
    v_dot2_f32_bf16 v31, v118, v6, v31
    v_dot2_f32_bf16 v31, v119, v7, v31
    s_nop 2
    v_add_f32_dpp v24, v24, v24 row_mirror row_mask:0xf bank_mask:0x3
    v_add_f32_dpp v25, v25, v25 row_mirror row_mask:0xf bank_mask:0x3
    v_add_f32_dpp v26, v26, v26 row_mirror row_mask:0xf bank_mask:0x3
    v_add_f32_dpp v27, v27, v27 row_mirror row_mask:0xf bank_mask:0x3
    v_add_f32_dpp v24, v28, v28 row_mirror row_mask:0xf bank_mask:0xc
    v_add_f32_dpp v25, v29, v29 row_mirror row_mask:0xf bank_mask:0xc
    v_add_f32_dpp v26, v30, v30 row_mirror row_mask:0xf bank_mask:0xc
    v_add_f32_dpp v27, v31, v31 row_mirror row_mask:0xf bank_mask:0xc
    s_nop 0
    v_add_f32_dpp v24, v24, v24 row_half_mirror row_mask:0xf bank_mask:0x5
    v_add_f32_dpp v25, v25, v25 row_half_mirror row_mask:0xf bank_mask:0x5
    s_nop 0
    v_add_f32_dpp v24, v26, v26 row_half_mirror row_mask:0xf bank_mask:0xa
    v_add_f32_dpp v25, v27, v27 row_half_mirror row_mask:0xf bank_mask:0xa
    s_nop 1
    v_add_f32_dpp v26, v24, v24 quad_perm:[2,3,0,1] row_mask:0xf bank_mask:0xf
    v_add_f32_dpp v27, v25, v25 quad_perm:[2,3,0,1] row_mask:0xf bank_mask:0xf
    s_nop 0
    v_cndmask_b32 v26, v26, v27, s[30:31]
    s_nop 1
    v_add_f32_dpp v26, v26, v26 quad_perm:[1,0,3,2] row_mask:0xf bank_mask:0xf
    v_cvt_pk_bf16_f32 v36, v26, v26
    v_and_b32 v36, 0xffff0000, v36
    v_mul_f32 v36, 0x3db504f3, v36
    v_cvt_pk_bf16_f32 v36, v36, v36
    v_and_b32 v26, 0xffff0000, v36
    v_cmp_gt_f32 vcc, v26, v35
    s_nop 1
    s_cbranch_vccnz L_upd_3
L_back_4:
    v_sub_f32 v36, v26, v35
    v_mul_f32 v36, 0x3fb8aa3b, v36
    v_exp_f32 v36, v36
    s_nop 0
    v_add_f32 v33, v33, v36
    v_cvt_pk_bf16_f32 v32, v36, v36
    s_nop 1
    s_waitcnt vmcnt(23)
    ds_read_b128 v[112:115], v43 offset:8192
    v_and_b32_dpp v12, v32, v8 row_newbcast:0 row_mask:0xf bank_mask:0xf
    v_and_b32_dpp v13, v32, v9 row_newbcast:0 row_mask:0xf bank_mask:0xf
    v_and_b32_dpp v14, v32, v10 row_newbcast:0 row_mask:0xf bank_mask:0xf
    v_and_b32_dpp v15, v32, v11 row_newbcast:0 row_mask:0xf bank_mask:0xf
    s_waitcnt lgkmcnt(0)
    s_nop 0
    v_mfma_f32_16x16x32_bf16 v[20:23], v[12:15], v[112:115], v[20:23]
    s_waitcnt vmcnt(22)
    ds_read_b128 v[116:119], v43 offset:9216
    v_and_b32_dpp v16, v32, v8 row_newbcast:2 row_mask:0xf bank_mask:0xf
    v_and_b32_dpp v17, v32, v9 row_newbcast:2 row_mask:0xf bank_mask:0xf
    v_and_b32_dpp v18, v32, v10 row_newbcast:2 row_mask:0xf bank_mask:0xf
    v_and_b32_dpp v19, v32, v11 row_newbcast:2 row_mask:0xf bank_mask:0xf
    s_waitcnt lgkmcnt(0)
    s_nop 0
    v_mfma_f32_16x16x32_bf16 v[20:23], v[16:19], v[116:119], v[20:23]
    s_waitcnt vmcnt(21)
    ds_read_b128 v[112:115], v43 offset:10240
    v_and_b32_dpp v12, v32, v8 row_newbcast:4 row_mask:0xf bank_mask:0xf
    v_and_b32_dpp v13, v32, v9 row_newbcast:4 row_mask:0xf bank_mask:0xf
    v_and_b32_dpp v14, v32, v10 row_newbcast:4 row_mask:0xf bank_mask:0xf
    v_and_b32_dpp v15, v32, v11 row_newbcast:4 row_mask:0xf bank_mask:0xf
    s_waitcnt lgkmcnt(0)
    s_nop 0
    v_mfma_f32_16x16x32_bf16 v[20:23], v[12:15], v[112:115], v[20:23]
    s_waitcnt vmcnt(20)
    ds_read_b128 v[116:119], v43 offset:11264
    v_and_b32_dpp v16, v32, v8 row_newbcast:6 row_mask:0xf bank_mask:0xf
    v_and_b32_dpp v17, v32, v9 row_newbcast:6 row_mask:0xf bank_mask:0xf
    v_and_b32_dpp v18, v32, v10 row_newbcast:6 row_mask:0xf bank_mask:0xf
    v_and_b32_dpp v19, v32, v11 row_newbcast:6 row_mask:0xf bank_mask:0xf
    s_waitcnt lgkmcnt(0)
    s_nop 0
    v_mfma_f32_16x16x32_bf16 v[20:23], v[16:19], v[116:119], v[20:23]
    s_waitcnt vmcnt(19)
    ds_read_b128 v[112:115], v43 offset:12288
    v_and_b32_dpp v12, v32, v8 row_newbcast:8 row_mask:0xf bank_mask:0xf
    v_and_b32_dpp v13, v32, v9 row_newbcast:8 row_mask:0xf bank_mask:0xf
    v_and_b32_dpp v14, v32, v10 row_newbcast:8 row_mask:0xf bank_mask:0xf
    v_and_b32_dpp v15, v32, v11 row_newbcast:8 row_mask:0xf bank_mask:0xf
    s_waitcnt lgkmcnt(0)
    s_nop 0
    v_mfma_f32_16x16x32_bf16 v[20:23], v[12:15], v[112:115], v[20:23]
    s_waitcnt vmcnt(18)
    ds_read_b128 v[116:119], v43 offset:13312
    v_and_b32_dpp v16, v32, v8 row_newbcast:10 row_mask:0xf bank_mask:0xf
    v_and_b32_dpp v17, v32, v9 row_newbcast:10 row_mask:0xf bank_mask:0xf
    v_and_b32_dpp v18, v32, v10 row_newbcast:10 row_mask:0xf bank_mask:0xf
    v_and_b32_dpp v19, v32, v11 row_newbcast:10 row_mask:0xf bank_mask:0xf
    s_waitcnt lgkmcnt(0)
    s_nop 0
    v_mfma_f32_16x16x32_bf16 v[20:23], v[16:19], v[116:119], v[20:23]
    s_waitcnt vmcnt(17)
    ds_read_b128 v[112:115], v43 offset:14336
    v_and_b32_dpp v12, v32, v8 row_newbcast:12 row_mask:0xf bank_mask:0xf
    v_and_b32_dpp v13, v32, v9 row_newbcast:12 row_mask:0xf bank_mask:0xf
    v_and_b32_dpp v14, v32, v10 row_newbcast:12 row_mask:0xf bank_mask:0xf
    v_and_b32_dpp v15, v32, v11 row_newbcast:12 row_mask:0xf bank_mask:0xf
    s_waitcnt lgkmcnt(0)
    s_nop 0
    v_mfma_f32_16x16x32_bf16 v[20:23], v[12:15], v[112:115], v[20:23]
    s_waitcnt vmcnt(16)
    ds_read_b128 v[116:119], v43 offset:15360
    v_and_b32_dpp v16, v32, v8 row_newbcast:14 row_mask:0xf bank_mask:0xf
    v_and_b32_dpp v17, v32, v9 row_newbcast:14 row_mask:0xf bank_mask:0xf
    v_and_b32_dpp v18, v32, v10 row_newbcast:14 row_mask:0xf bank_mask:0xf
    v_and_b32_dpp v19, v32, v11 row_newbcast:14 row_mask:0xf bank_mask:0xf
    s_waitcnt lgkmcnt(0)
    s_nop 0
    v_mfma_f32_16x16x32_bf16 v[20:23], v[16:19], v[116:119], v[20:23]
    v_mov_b32 v41, 1
    s_mov_b64 exec, 1
    ds_add_u32 v42, v41 offset:4
    s_mov_b64 exec, -1
    s_mov_b32 s20, s28
    s_mov_b32 s21, s29
    s_waitcnt vmcnt(15)
    v_dot2_f32_bf16 v24, v48, v4, 0
    v_dot2_f32_bf16 v24, v49, v5, v24
    v_dot2_f32_bf16 v24, v50, v6, v24
    v_dot2_f32_bf16 v24, v51, v7, v24
    s_waitcnt vmcnt(14)
    v_dot2_f32_bf16 v25, v52, v4, 0
    v_dot2_f32_bf16 v25, v53, v5, v25
    v_dot2_f32_bf16 v25, v54, v6, v25
    v_dot2_f32_bf16 v25, v55, v7, v25
    s_waitcnt vmcnt(13)
    v_dot2_f32_bf16 v26, v56, v4, 0
    v_dot2_f32_bf16 v26, v57, v5, v26
    v_dot2_f32_bf16 v26, v58, v6, v26
    v_dot2_f32_bf16 v26, v59, v7, v26
    s_waitcnt vmcnt(12)
    v_dot2_f32_bf16 v27, v60, v4, 0
    v_dot2_f32_bf16 v27, v61, v5, v27
    v_dot2_f32_bf16 v27, v62, v6, v27
    v_dot2_f32_bf16 v27, v63, v7, v27
    s_waitcnt vmcnt(11)
    v_dot2_f32_bf16 v28, v64, v4, 0
    v_dot2_f32_bf16 v28, v65, v5, v28
    v_dot2_f32_bf16 v28, v66, v6, v28
    v_dot2_f32_bf16 v28, v67, v7, v28
    s_waitcnt vmcnt(10)
    v_dot2_f32_bf16 v29, v68, v4, 0
    v_dot2_f32_bf16 v29, v69, v5, v29
    v_dot2_f32_bf16 v29, v70, v6, v29
    v_dot2_f32_bf16 v29, v71, v7, v29
    s_waitcnt vmcnt(9)
    v_dot2_f32_bf16 v30, v72, v4, 0
    v_dot2_f32_bf16 v30, v73, v5, v30
    v_dot2_f32_bf16 v30, v74, v6, v30
    v_dot2_f32_bf16 v30, v75, v7, v30
    s_waitcnt vmcnt(8)
    v_dot2_f32_bf16 v31, v76, v4, 0
    v_dot2_f32_bf16 v31, v77, v5, v31
    v_dot2_f32_bf16 v31, v78, v6, v31
    v_dot2_f32_bf16 v31, v79, v7, v31
    s_nop 2
    v_add_f32_dpp v24, v24, v24 row_mirror row_mask:0xf bank_mask:0x3
    v_add_f32_dpp v25, v25, v25 row_mirror row_mask:0xf bank_mask:0x3
    v_add_f32_dpp v26, v26, v26 row_mirror row_mask:0xf bank_mask:0x3
    v_add_f32_dpp v27, v27, v27 row_mirror row_mask:0xf bank_mask:0x3
    v_add_f32_dpp v24, v28, v28 row_mirror row_mask:0xf bank_mask:0xc
    v_add_f32_dpp v25, v29, v29 row_mirror row_mask:0xf bank_mask:0xc
    v_add_f32_dpp v26, v30, v30 row_mirror row_mask:0xf bank_mask:0xc
    v_add_f32_dpp v27, v31, v31 row_mirror row_mask:0xf bank_mask:0xc
    s_nop 0
    v_add_f32_dpp v24, v24, v24 row_half_mirror row_mask:0xf bank_mask:0x5
    v_add_f32_dpp v25, v25, v25 row_half_mirror row_mask:0xf bank_mask:0x5
    s_nop 0
    v_add_f32_dpp v24, v26, v26 row_half_mirror row_mask:0xf bank_mask:0xa
    v_add_f32_dpp v25, v27, v27 row_half_mirror row_mask:0xf bank_mask:0xa
    s_nop 1
    v_add_f32_dpp v26, v24, v24 quad_perm:[2,3,0,1] row_mask:0xf bank_mask:0xf
    v_add_f32_dpp v27, v25, v25 quad_perm:[2,3,0,1] row_mask:0xf bank_mask:0xf
    s_nop 0
    v_cndmask_b32 v26, v26, v27, s[30:31]
    s_nop 1
    v_add_f32_dpp v26, v26, v26 quad_perm:[1,0,3,2] row_mask:0xf bank_mask:0xf
    v_cvt_pk_bf16_f32 v36, v26, v26
    v_and_b32 v36, 0xffff0000, v36
    v_mul_f32 v36, 0x3db504f3, v36
    v_cvt_pk_bf16_f32 v36, v36, v36
    v_and_b32 v26, 0xffff0000, v36
    v_cmp_gt_f32 vcc, v26, v35
    s_nop 1
    s_cbranch_vccnz L_upd_5
L_back_6:
    v_sub_f32 v36, v26, v35
    v_mul_f32 v36, 0x3fb8aa3b, v36
    v_exp_f32 v36, v36
    s_nop 0
    v_add_f32 v33, v33, v36
    v_cvt_pk_bf16_f32 v32, v36, v36
    s_nop 1
    v_and_b32_dpp v12, v32, v8 row_newbcast:0 row_mask:0xf bank_mask:0xf
    v_and_b32_dpp v13, v32, v9 row_newbcast:0 row_mask:0xf bank_mask:0xf
    v_and_b32_dpp v14, v32, v10 row_newbcast:0 row_mask:0xf bank_mask:0xf
    v_and_b32_dpp v15, v32, v11 row_newbcast:0 row_mask:0xf bank_mask:0xf
    s_waitcnt vmcnt(7)
    s_nop 0
    v_mfma_f32_16x16x32_bf16 v[20:23], v[12:15], v[80:83], v[20:23]
    v_and_b32_dpp v16, v32, v8 row_newbcast:2 row_mask:0xf bank_mask:0xf
    v_and_b32_dpp v17, v32, v9 row_newbcast:2 row_mask:0xf bank_mask:0xf
    v_and_b32_dpp v18, v32, v10 row_newbcast:2 row_mask:0xf bank_mask:0xf
    v_and_b32_dpp v19, v32, v11 row_newbcast:2 row_mask:0xf bank_mask:0xf
    s_waitcnt vmcnt(6)
    s_nop 0
    v_mfma_f32_16x16x32_bf16 v[20:23], v[16:19], v[84:87], v[20:23]
    v_and_b32_dpp v12, v32, v8 row_newbcast:4 row_mask:0xf bank_mask:0xf
    v_and_b32_dpp v13, v32, v9 row_newbcast:4 row_mask:0xf bank_mask:0xf
    v_and_b32_dpp v14, v32, v10 row_newbcast:4 row_mask:0xf bank_mask:0xf
    v_and_b32_dpp v15, v32, v11 row_newbcast:4 row_mask:0xf bank_mask:0xf
    s_waitcnt vmcnt(5)
    s_nop 0
    v_mfma_f32_16x16x32_bf16 v[20:23], v[12:15], v[88:91], v[20:23]
    v_mov_b32 v41, 1
    s_mov_b64 exec, 1
    ds_add_rtn_u32 v41, v42, v41 offset:0
    s_mov_b64 exec, -1
    s_waitcnt lgkmcnt(0)
    v_readfirstlane_b32 s22, v41
    s_nop 0
    s_cmp_ge_u32 s22, 96
    s_cbranch_scc1 L_dyn_7
    s_add_u32 s22, s22, s47
    s_lshl_b32 s22, s22, 13
L_have_8:
    s_add_u32 s23, s22, 4096
    v_and_b32_dpp v16, v32, v8 row_newbcast:6 row_mask:0xf bank_mask:0xf
    v_and_b32_dpp v17, v32, v9 row_newbcast:6 row_mask:0xf bank_mask:0xf
    v_and_b32_dpp v18, v32, v10 row_newbcast:6 row_mask:0xf bank_mask:0xf
    v_and_b32_dpp v19, v32, v11 row_newbcast:6 row_mask:0xf bank_mask:0xf
    s_waitcnt vmcnt(4)
    buffer_load_dwordx4 v[48:51], v1, s[8:11], s22 offen offset:0 nt
    v_mfma_f32_16x16x32_bf16 v[20:23], v[16:19], v[92:95], v[20:23]
    v_and_b32_dpp v12, v32, v8 row_newbcast:8 row_mask:0xf bank_mask:0xf
    v_and_b32_dpp v13, v32, v9 row_newbcast:8 row_mask:0xf bank_mask:0xf
    v_and_b32_dpp v14, v32, v10 row_newbcast:8 row_mask:0xf bank_mask:0xf
    v_and_b32_dpp v15, v32, v11 row_newbcast:8 row_mask:0xf bank_mask:0xf
    s_waitcnt vmcnt(4)
    buffer_load_dwordx4 v[52:55], v1, s[8:11], s22 offen offset:1024 nt
    v_mfma_f32_16x16x32_bf16 v[20:23], v[12:15], v[96:99], v[20:23]
    v_and_b32_dpp v16, v32, v8 row_newbcast:10 row_mask:0xf bank_mask:0xf
    v_and_b32_dpp v17, v32, v9 row_newbcast:10 row_mask:0xf bank_mask:0xf
    v_and_b32_dpp v18, v32, v10 row_newbcast:10 row_mask:0xf bank_mask:0xf
    v_and_b32_dpp v19, v32, v11 row_newbcast:10 row_mask:0xf bank_mask:0xf
    s_waitcnt vmcnt(4)
    buffer_load_dwordx4 v[56:59], v1, s[8:11], s22 offen offset:2048 nt
    v_mfma_f32_16x16x32_bf16 v[20:23], v[16:19], v[100:103], v[20:23]
    v_and_b32_dpp v12, v32, v8 row_newbcast:12 row_mask:0xf bank_mask:0xf
    v_and_b32_dpp v13, v32, v9 row_newbcast:12 row_mask:0xf bank_mask:0xf
    v_and_b32_dpp v14, v32, v10 row_newbcast:12 row_mask:0xf bank_mask:0xf
    v_and_b32_dpp v15, v32, v11 row_newbcast:12 row_mask:0xf bank_mask:0xf
    s_waitcnt vmcnt(4)
    buffer_load_dwordx4 v[60:63], v1, s[8:11], s22 offen offset:3072 nt
    v_mfma_f32_16x16x32_bf16 v[20:23], v[12:15], v[104:107], v[20:23]
    v_and_b32_dpp v16, v32, v8 row_newbcast:14 row_mask:0xf bank_mask:0xf
    v_and_b32_dpp v17, v32, v9 row_newbcast:14 row_mask:0xf bank_mask:0xf
    v_and_b32_dpp v18, v32, v10 row_newbcast:14 row_mask:0xf bank_mask:0xf
    v_and_b32_dpp v19, v32, v11 row_newbcast:14 row_mask:0xf bank_mask:0xf
    s_waitcnt vmcnt(4)
    buffer_load_dwordx4 v[64:67], v1, s[8:11], s23 offen offset:0 nt
    v_mfma_f32_16x16x32_bf16 v[20:23], v[16:19], v[108:111], v[20:23]
    s_mov_b32 s20, s22
    s_mov_b32 s21, s23
L_loop:
    s_waitcnt vmcnt(4)
    v_dot2_f32_bf16 v24, v48, v4, 0
    v_dot2_f32_bf16 v24, v49, v5, v24
    v_dot2_f32_bf16 v24, v50, v6, v24
    v_dot2_f32_bf16 v24, v51, v7, v24
    buffer_load_dwordx4 v[68:71], v1, s[8:11], s21 offen offset:1024 nt
    s_waitcnt vmcnt(4)
    v_dot2_f32_bf16 v25, v52, v4, 0
    v_dot2_f32_bf16 v25, v53, v5, v25
    v_dot2_f32_bf16 v25, v54, v6, v25
    v_dot2_f32_bf16 v25, v55, v7, v25
    buffer_load_dwordx4 v[72:75], v1, s[8:11], s21 offen offset:2048 nt
    s_waitcnt vmcnt(4)
    v_dot2_f32_bf16 v26, v56, v4, 0
    v_dot2_f32_bf16 v26, v57, v5, v26
    v_dot2_f32_bf16 v26, v58, v6, v26
    v_dot2_f32_bf16 v26, v59, v7, v26
    buffer_load_dwordx4 v[76:79], v1, s[8:11], s21 offen offset:3072 nt
    s_waitcnt vmcnt(4)
    v_dot2_f32_bf16 v27, v60, v4, 0
    v_dot2_f32_bf16 v27, v61, v5, v27
    v_dot2_f32_bf16 v27, v62, v6, v27
    v_dot2_f32_bf16 v27, v63, v7, v27
    buffer_load_dwordx4 v[80:83], v1, s[12:15], s20 offen offset:0 nt
    s_waitcnt vmcnt(4)
    v_dot2_f32_bf16 v28, v64, v4, 0
    v_dot2_f32_bf16 v28, v65, v5, v28
    v_dot2_f32_bf16 v28, v66, v6, v28
    v_dot2_f32_bf16 v28, v67, v7, v28
    buffer_load_dwordx4 v[84:87], v1, s[12:15], s20 offen offset:1024 nt
    s_waitcnt vmcnt(4)
    v_dot2_f32_bf16 v29, v68, v4, 0
    v_dot2_f32_bf16 v29, v69, v5, v29
    v_dot2_f32_bf16 v29, v70, v6, v29
    v_dot2_f32_bf16 v29, v71, v7, v29
    buffer_load_dwordx4 v[88:91], v1, s[12:15], s20 offen offset:2048 nt
    s_waitcnt vmcnt(4)
    v_dot2_f32_bf16 v30, v72, v4, 0
    v_dot2_f32_bf16 v30, v73, v5, v30
    v_dot2_f32_bf16 v30, v74, v6, v30
    v_dot2_f32_bf16 v30, v75, v7, v30
    buffer_load_dwordx4 v[92:95], v1, s[12:15], s20 offen offset:3072 nt
    s_waitcnt vmcnt(4)
    v_dot2_f32_bf16 v31, v76, v4, 0
    v_dot2_f32_bf16 v31, v77, v5, v31
    v_dot2_f32_bf16 v31, v78, v6, v31
    v_dot2_f32_bf16 v31, v79, v7, v31
    buffer_load_dwordx4 v[96:99], v1, s[12:15], s21 offen offset:0 nt
    s_nop 2
    v_add_f32_dpp v24, v24, v24 row_mirror row_mask:0xf bank_mask:0x3
    v_add_f32_dpp v25, v25, v25 row_mirror row_mask:0xf bank_mask:0x3
    v_add_f32_dpp v26, v26, v26 row_mirror row_mask:0xf bank_mask:0x3
    v_add_f32_dpp v27, v27, v27 row_mirror row_mask:0xf bank_mask:0x3
    v_add_f32_dpp v24, v28, v28 row_mirror row_mask:0xf bank_mask:0xc
    v_add_f32_dpp v25, v29, v29 row_mirror row_mask:0xf bank_mask:0xc
    v_add_f32_dpp v26, v30, v30 row_mirror row_mask:0xf bank_mask:0xc
    v_add_f32_dpp v27, v31, v31 row_mirror row_mask:0xf bank_mask:0xc
    s_nop 0
    v_add_f32_dpp v24, v24, v24 row_half_mirror row_mask:0xf bank_mask:0x5
    v_add_f32_dpp v25, v25, v25 row_half_mirror row_mask:0xf bank_mask:0x5
    s_nop 0
    v_add_f32_dpp v24, v26, v26 row_half_mirror row_mask:0xf bank_mask:0xa
    v_add_f32_dpp v25, v27, v27 row_half_mirror row_mask:0xf bank_mask:0xa
    s_nop 1
    v_add_f32_dpp v26, v24, v24 quad_perm:[2,3,0,1] row_mask:0xf bank_mask:0xf
    v_add_f32_dpp v27, v25, v25 quad_perm:[2,3,0,1] row_mask:0xf bank_mask:0xf
    s_nop 0
    v_cndmask_b32 v26, v26, v27, s[30:31]
    s_nop 1
    v_add_f32_dpp v26, v26, v26 quad_perm:[1,0,3,2] row_mask:0xf bank_mask:0xf
    v_cvt_pk_bf16_f32 v36, v26, v26
    v_and_b32 v36, 0xffff0000, v36
    v_mul_f32 v36, 0x3db504f3, v36
    v_cvt_pk_bf16_f32 v36, v36, v36
    v_and_b32 v26, 0xffff0000, v36
    v_cmp_gt_f32 vcc, v26, v35
    s_nop 1
    s_cbranch_vccnz L_upd_10
L_back_11:
    v_sub_f32 v36, v26, v35
    v_mul_f32 v36, 0x3fb8aa3b, v36
    v_exp_f32 v36, v36
    s_nop 0
    v_add_f32 v33, v33, v36
    v_cvt_pk_bf16_f32 v32, v36, v36
    s_nop 1
    v_and_b32_dpp v12, v32, v8 row_newbcast:0 row_mask:0xf bank_mask:0xf
    v_and_b32_dpp v13, v32, v9 row_newbcast:0 row_mask:0xf bank_mask:0xf
    v_and_b32_dpp v14, v32, v10 row_newbcast:0 row_mask:0xf bank_mask:0xf
    v_and_b32_dpp v15, v32, v11 row_newbcast:0 row_mask:0xf bank_mask:0xf
    s_waitcnt vmcnt(4)
    buffer_load_dwordx4 v[100:103], v1, s[12:15], s21 offen offset:1024 nt
    v_mfma_f32_16x16x32_bf16 v[20:23], v[12:15], v[80:83], v[20:23]
    v_and_b32_dpp v16, v32, v8 row_newbcast:2 row_mask:0xf bank_mask:0xf
    v_and_b32_dpp v17, v32, v9 row_newbcast:2 row_mask:0xf bank_mask:0xf
    v_and_b32_dpp v18, v32, v10 row_newbcast:2 row_mask:0xf bank_mask:0xf
    v_and_b32_dpp v19, v32, v11 row_newbcast:2 row_mask:0xf bank_mask:0xf
    s_waitcnt vmcnt(4)
    buffer_load_dwordx4 v[104:107], v1, s[12:15], s21 offen offset:2048 nt
    v_mfma_f32_16x16x32_bf16 v[20:23], v[16:19], v[84:87], v[20:23]
    v_and_b32_dpp v12, v32, v8 row_newbcast:4 row_mask:0xf bank_mask:0xf
    v_and_b32_dpp v13, v32, v9 row_newbcast:4 row_mask:0xf bank_mask:0xf
    v_and_b32_dpp v14, v32, v10 row_newbcast:4 row_mask:0xf bank_mask:0xf
    v_and_b32_dpp v15, v32, v11 row_newbcast:4 row_mask:0xf bank_mask:0xf
    s_waitcnt vmcnt(4)
    buffer_load_dwordx4 v[108:111], v1, s[12:15], s21 offen offset:3072 nt
    v_mfma_f32_16x16x32_bf16 v[20:23], v[12:15], v[88:91], v[20:23]
    v_mov_b32 v41, 1
    s_mov_b64 exec, 1
    ds_add_rtn_u32 v41, v42, v41 offset:0
    s_mov_b64 exec, -1
    s_waitcnt lgkmcnt(0)
    v_readfirstlane_b32 s22, v41
    s_nop 0
    s_cmp_ge_u32 s22, 96
    s_cbranch_scc1 L_dyn_12
    s_add_u32 s22, s22, s47
    s_lshl_b32 s22, s22, 13
L_have_13:
    s_add_u32 s23, s22, 4096
    v_and_b32_dpp v16, v32, v8 row_newbcast:6 row_mask:0xf bank_mask:0xf
    v_and_b32_dpp v17, v32, v9 row_newbcast:6 row_mask:0xf bank_mask:0xf
    v_and_b32_dpp v18, v32, v10 row_newbcast:6 row_mask:0xf bank_mask:0xf
    v_and_b32_dpp v19, v32, v11 row_newbcast:6 row_mask:0xf bank_mask:0xf
    s_waitcnt vmcnt(4)
    buffer_load_dwordx4 v[48:51], v1, s[8:11], s22 offen offset:0 nt
    v_mfma_f32_16x16x32_bf16 v[20:23], v[16:19], v[92:95], v[20:23]
    v_and_b32_dpp v12, v32, v8 row_newbcast:8 row_mask:0xf bank_mask:0xf
    v_and_b32_dpp v13, v32, v9 row_newbcast:8 row_mask:0xf bank_mask:0xf
    v_and_b32_dpp v14, v32, v10 row_newbcast:8 row_mask:0xf bank_mask:0xf
    v_and_b32_dpp v15, v32, v11 row_newbcast:8 row_mask:0xf bank_mask:0xf
    s_waitcnt vmcnt(4)
    buffer_load_dwordx4 v[52:55], v1, s[8:11], s22 offen offset:1024 nt
    v_mfma_f32_16x16x32_bf16 v[20:23], v[12:15], v[96:99], v[20:23]
    v_and_b32_dpp v16, v32, v8 row_newbcast:10 row_mask:0xf bank_mask:0xf
    v_and_b32_dpp v17, v32, v9 row_newbcast:10 row_mask:0xf bank_mask:0xf
    v_and_b32_dpp v18, v32, v10 row_newbcast:10 row_mask:0xf bank_mask:0xf
    v_and_b32_dpp v19, v32, v11 row_newbcast:10 row_mask:0xf bank_mask:0xf
    s_waitcnt vmcnt(4)
    buffer_load_dwordx4 v[56:59], v1, s[8:11], s22 offen offset:2048 nt
    v_mfma_f32_16x16x32_bf16 v[20:23], v[16:19], v[100:103], v[20:23]
    v_and_b32_dpp v12, v32, v8 row_newbcast:12 row_mask:0xf bank_mask:0xf
    v_and_b32_dpp v13, v32, v9 row_newbcast:12 row_mask:0xf bank_mask:0xf
    v_and_b32_dpp v14, v32, v10 row_newbcast:12 row_mask:0xf bank_mask:0xf
    v_and_b32_dpp v15, v32, v11 row_newbcast:12 row_mask:0xf bank_mask:0xf
    s_waitcnt vmcnt(4)
    buffer_load_dwordx4 v[60:63], v1, s[8:11], s22 offen offset:3072 nt
    v_mfma_f32_16x16x32_bf16 v[20:23], v[12:15], v[104:107], v[20:23]
    v_and_b32_dpp v16, v32, v8 row_newbcast:14 row_mask:0xf bank_mask:0xf
    v_and_b32_dpp v17, v32, v9 row_newbcast:14 row_mask:0xf bank_mask:0xf
    v_and_b32_dpp v18, v32, v10 row_newbcast:14 row_mask:0xf bank_mask:0xf
    v_and_b32_dpp v19, v32, v11 row_newbcast:14 row_mask:0xf bank_mask:0xf
    s_waitcnt vmcnt(4)
    buffer_load_dwordx4 v[64:67], v1, s[8:11], s23 offen offset:0 nt
    v_mfma_f32_16x16x32_bf16 v[20:23], v[16:19], v[108:111], v[20:23]
    s_mov_b32 s20, s22
    s_mov_b32 s21, s23
    s_branch L_loop
L_last:
    v_and_b32_dpp v16, v32, v8 row_newbcast:6 row_mask:0xf bank_mask:0xf
    v_and_b32_dpp v17, v32, v9 row_newbcast:6 row_mask:0xf bank_mask:0xf
    v_and_b32_dpp v18, v32, v10 row_newbcast:6 row_mask:0xf bank_mask:0xf
    v_and_b32_dpp v19, v32, v11 row_newbcast:6 row_mask:0xf bank_mask:0xf
    s_waitcnt vmcnt(4)
    s_nop 0
    v_mfma_f32_16x16x32_bf16 v[20:23], v[16:19], v[92:95], v[20:23]
    v_and_b32_dpp v12, v32, v8 row_newbcast:8 row_mask:0xf bank_mask:0xf
    v_and_b32_dpp v13, v32, v9 row_newbcast:8 row_mask:0xf bank_mask:0xf
    v_and_b32_dpp v14, v32, v10 row_newbcast:8 row_mask:0xf bank_mask:0xf
    v_and_b32_dpp v15, v32, v11 row_newbcast:8 row_mask:0xf bank_mask:0xf
    s_waitcnt vmcnt(3)
    s_nop 0
    v_mfma_f32_16x16x32_bf16 v[20:23], v[12:15], v[96:99], v[20:23]
    v_and_b32_dpp v16, v32, v8 row_newbcast:10 row_mask:0xf bank_mask:0xf
    v_and_b32_dpp v17, v32, v9 row_newbcast:10 row_mask:0xf bank_mask:0xf
    v_and_b32_dpp v18, v32, v10 row_newbcast:10 row_mask:0xf bank_mask:0xf
    v_and_b32_dpp v19, v32, v11 row_newbcast:10 row_mask:0xf bank_mask:0xf
    s_waitcnt vmcnt(2)
    s_nop 0
    v_mfma_f32_16x16x32_bf16 v[20:23], v[16:19], v[100:103], v[20:23]
    v_and_b32_dpp v12, v32, v8 row_newbcast:12 row_mask:0xf bank_mask:0xf
    v_and_b32_dpp v13, v32, v9 row_newbcast:12 row_mask:0xf bank_mask:0xf
    v_and_b32_dpp v14, v32, v10 row_newbcast:12 row_mask:0xf bank_mask:0xf
    v_and_b32_dpp v15, v32, v11 row_newbcast:12 row_mask:0xf bank_mask:0xf
    s_waitcnt vmcnt(1)
    s_nop 0
    v_mfma_f32_16x16x32_bf16 v[20:23], v[12:15], v[104:107], v[20:23]
    v_and_b32_dpp v16, v32, v8 row_newbcast:14 row_mask:0xf bank_mask:0xf
    v_and_b32_dpp v17, v32, v9 row_newbcast:14 row_mask:0xf bank_mask:0xf
    v_and_b32_dpp v18, v32, v10 row_newbcast:14 row_mask:0xf bank_mask:0xf
    v_and_b32_dpp v19, v32, v11 row_newbcast:14 row_mask:0xf bank_mask:0xf
    s_waitcnt vmcnt(0)
    s_nop 0
    v_mfma_f32_16x16x32_bf16 v[20:23], v[16:19], v[108:111], v[20:23]
    s_branch L_streamdone
L_trans:
    v_and_b32_dpp v16, v32, v8 row_newbcast:6 row_mask:0xf bank_mask:0xf
    v_and_b32_dpp v17, v32, v9 row_newbcast:6 row_mask:0xf bank_mask:0xf
    v_and_b32_dpp v18, v32, v10 row_newbcast:6 row_mask:0xf bank_mask:0xf
    v_and_b32_dpp v19, v32, v11 row_newbcast:6 row_mask:0xf bank_mask:0xf
    s_waitcnt vmcnt(4)
    buffer_load_dwordx4 v[48:51], v1, s[8:11], s22 offen offset:0 nt
    v_mfma_f32_16x16x32_bf16 v[20:23], v[16:19], v[92:95], v[20:23]
    v_and_b32_dpp v12, v32, v8 row_newbcast:8 row_mask:0xf bank_mask:0xf
    v_and_b32_dpp v13, v32, v9 row_newbcast:8 row_mask:0xf bank_mask:0xf
    v_and_b32_dpp v14, v32, v10 row_newbcast:8 row_mask:0xf bank_mask:0xf
    v_and_b32_dpp v15, v32, v11 row_newbcast:8 row_mask:0xf bank_mask:0xf
    s_waitcnt vmcnt(4)
    buffer_load_dwordx4 v[52:55], v1, s[8:11], s22 offen offset:1024 nt
    v_mfma_f32_16x16x32_bf16 v[20:23], v[12:15], v[96:99], v[20:23]
    v_and_b32_dpp v16, v32, v8 row_newbcast:10 row_mask:0xf bank_mask:0xf
    v_and_b32_dpp v17, v32, v9 row_newbcast:10 row_mask:0xf bank_mask:0xf
    v_and_b32_dpp v18, v32, v10 row_newbcast:10 row_mask:0xf bank_mask:0xf
    v_and_b32_dpp v19, v32, v11 row_newbcast:10 row_mask:0xf bank_mask:0xf
    s_waitcnt vmcnt(4)
    buffer_load_dwordx4 v[56:59], v1, s[8:11], s22 offen offset:2048 nt
    v_mfma_f32_16x16x32_bf16 v[20:23], v[16:19], v[100:103], v[20:23]
    v_and_b32_dpp v12, v32, v8 row_newbcast:12 row_mask:0xf bank_mask:0xf
    v_and_b32_dpp v13, v32, v9 row_newbcast:12 row_mask:0xf bank_mask:0xf
    v_and_b32_dpp v14, v32, v10 row_newbcast:12 row_mask:0xf bank_mask:0xf
    v_and_b32_dpp v15, v32, v11 row_newbcast:12 row_mask:0xf bank_mask:0xf
    s_waitcnt vmcnt(4)
    buffer_load_dwordx4 v[60:63], v1, s[8:11], s22 offen offset:3072 nt
    v_mfma_f32_16x16x32_bf16 v[20:23], v[12:15], v[104:107], v[20:23]
    v_and_b32_dpp v16, v32, v8 row_newbcast:14 row_mask:0xf bank_mask:0xf
    v_and_b32_dpp v17, v32, v9 row_newbcast:14 row_mask:0xf bank_mask:0xf
    v_and_b32_dpp v18, v32, v10 row_newbcast:14 row_mask:0xf bank_mask:0xf
    v_and_b32_dpp v19, v32, v11 row_newbcast:14 row_mask:0xf bank_mask:0xf
    s_waitcnt vmcnt(4)
    buffer_load_dwordx4 v[80:83], v1, s[12:15], s22 offen offset:0 nt
    v_mfma_f32_16x16x32_bf16 v[20:23], v[16:19], v[108:111], v[20:23]
    s_mov_b32 s20, s22
L_hloop:
    s_waitcnt vmcnt(4)
    v_dot2_f32_bf16 v24, v48, v4, 0
    v_dot2_f32_bf16 v24, v49, v5, v24
    v_dot2_f32_bf16 v24, v50, v6, v24
    v_dot2_f32_bf16 v24, v51, v7, v24
    buffer_load_dwordx4 v[84:87], v1, s[12:15], s20 offen offset:1024 nt
    s_waitcnt vmcnt(4)
    v_dot2_f32_bf16 v25, v52, v4, 0
    v_dot2_f32_bf16 v25, v53, v5, v25
    v_dot2_f32_bf16 v25, v54, v6, v25
    v_dot2_f32_bf16 v25, v55, v7, v25
    buffer_load_dwordx4 v[88:91], v1, s[12:15], s20 offen offset:2048 nt
    s_waitcnt vmcnt(4)
    v_dot2_f32_bf16 v26, v56, v4, 0
    v_dot2_f32_bf16 v26, v57, v5, v26
    v_dot2_f32_bf16 v26, v58, v6, v26
    v_dot2_f32_bf16 v26, v59, v7, v26
    buffer_load_dwordx4 v[92:95], v1, s[12:15], s20 offen offset:3072 nt
    v_mov_b32 v41, 1
    s_mov_b64 exec, 1
    ds_add_rtn_u32 v41, v42, v41 offset:0
    s_mov_b64 exec, -1
    s_waitcnt lgkmcnt(0)
    v_readfirstlane_b32 s22, v41
    s_branch L_dyn_17
L_have_18:
    s_waitcnt vmcnt(4)
    v_dot2_f32_bf16 v27, v60, v4, 0
    v_dot2_f32_bf16 v27, v61, v5, v27
    v_dot2_f32_bf16 v27, v62, v6, v27
    v_dot2_f32_bf16 v27, v63, v7, v27
    buffer_load_dwordx4 v[48:51], v1, s[8:11], s22 offen offset:0 nt
    v_add_f32_dpp v24, v24, v24 row_mirror row_mask:0xf bank_mask:0x3
    v_add_f32_dpp v25, v25, v25 row_mirror row_mask:0xf bank_mask:0x3
    s_nop 0
    v_add_f32_dpp v24, v26, v26 row_mirror row_mask:0xf bank_mask:0xc
    v_add_f32_dpp v25, v27, v27 row_mirror row_mask:0xf bank_mask:0xc
    s_nop 0
    v_add_f32_dpp v24, v24, v24 row_half_mirror row_mask:0xf bank_mask:0x5
    s_nop 1
    v_add_f32_dpp v24, v25, v25 row_half_mirror row_mask:0xf bank_mask:0xa
    s_nop 1
    v_add_f32_dpp v24, v24, v24 quad_perm:[2,3,0,1] row_mask:0xf bank_mask:0xf
    s_nop 1
    v_add_f32_dpp v24, v24, v24 quad_perm:[1,0,3,2] row_mask:0xf bank_mask:0xf
    v_cvt_pk_bf16_f32 v36, v24, v24
    v_and_b32 v36, 0xffff0000, v36
    v_mul_f32 v36, 0x3db504f3, v36
    v_cvt_pk_bf16_f32 v36, v36, v36
    v_and_b32 v26, 0xffff0000, v36
    v_cmp_gt_f32 vcc, v26, v35
    s_nop 1
    s_cbranch_vccnz L_upd_15
L_back_16:
    v_sub_f32 v36, v26, v35
    v_mul_f32 v36, 0x3fb8aa3b, v36
    v_exp_f32 v36, v36
    s_nop 0
    v_fmac_f32 v33, 0.5, v36
    v_cvt_pk_bf16_f32 v32, v36, v36
    s_nop 1
    v_and_b32_dpp v12, v32, v8 row_newbcast:0 row_mask:0xf bank_mask:0xf
    v_and_b32_dpp v13, v32, v9 row_newbcast:0 row_mask:0xf bank_mask:0xf
    v_and_b32_dpp v14, v32, v10 row_newbcast:0 row_mask:0xf bank_mask:0xf
    v_and_b32_dpp v15, v32, v11 row_newbcast:0 row_mask:0xf bank_mask:0xf
    s_waitcnt vmcnt(4)
    buffer_load_dwordx4 v[52:55], v1, s[8:11], s22 offen offset:1024 nt
    v_mfma_f32_16x16x32_bf16 v[20:23], v[12:15], v[80:83], v[20:23]
    v_and_b32_dpp v16, v32, v8 row_newbcast:4 row_mask:0xf bank_mask:0xf
    v_and_b32_dpp v17, v32, v9 row_newbcast:4 row_mask:0xf bank_mask:0xf
    v_and_b32_dpp v18, v32, v10 row_newbcast:4 row_mask:0xf bank_mask:0xf
    v_and_b32_dpp v19, v32, v11 row_newbcast:4 row_mask:0xf bank_mask:0xf
    s_waitcnt vmcnt(4)
    buffer_load_dwordx4 v[56:59], v1, s[8:11], s22 offen offset:2048 nt
    v_mfma_f32_16x16x32_bf16 v[20:23], v[16:19], v[84:87], v[20:23]
    v_and_b32_dpp v12, v32, v8 row_newbcast:8 row_mask:0xf bank_mask:0xf
    v_and_b32_dpp v13, v32, v9 row_newbcast:8 row_mask:0xf bank_mask:0xf
    v_and_b32_dpp v14, v32, v10 row_newbcast:8 row_mask:0xf bank_mask:0xf
    v_and_b32_dpp v15, v32, v11 row_newbcast:8 row_mask:0xf bank_mask:0xf
    s_waitcnt vmcnt(4)
    buffer_load_dwordx4 v[60:63], v1, s[8:11], s22 offen offset:3072 nt
    v_mfma_f32_16x16x32_bf16 v[20:23], v[12:15], v[88:91], v[20:23]
    v_and_b32_dpp v16, v32, v8 row_newbcast:12 row_mask:0xf bank_mask:0xf
    v_and_b32_dpp v17, v32, v9 row_newbcast:12 row_mask:0xf bank_mask:0xf
    v_and_b32_dpp v18, v32, v10 row_newbcast:12 row_mask:0xf bank_mask:0xf
    v_and_b32_dpp v19, v32, v11 row_newbcast:12 row_mask:0xf bank_mask:0xf
    s_waitcnt vmcnt(4)
    buffer_load_dwordx4 v[80:83], v1, s[12:15], s22 offen offset:0 nt
    v_mfma_f32_16x16x32_bf16 v[20:23], v[16:19], v[92:95], v[20:23]
    s_mov_b32 s20, s22
    s_branch L_hloop
L_hlast:
    s_waitcnt vmcnt(4)
    v_dot2_f32_bf16 v27, v60, v4, 0
    v_dot2_f32_bf16 v27, v61, v5, v27
    v_dot2_f32_bf16 v27, v62, v6, v27
    v_dot2_f32_bf16 v27, v63, v7, v27
    v_add_f32_dpp v24, v24, v24 row_mirror row_mask:0xf bank_mask:0x3
    v_add_f32_dpp v25, v25, v25 row_mirror row_mask:0xf bank_mask:0x3
    s_nop 0
    v_add_f32_dpp v24, v26, v26 row_mirror row_mask:0xf bank_mask:0xc
    v_add_f32_dpp v25, v27, v27 row_mirror row_mask:0xf bank_mask:0xc
    s_nop 0
    v_add_f32_dpp v24, v24, v24 row_half_mirror row_mask:0xf bank_mask:0x5
    s_nop 1
    v_add_f32_dpp v24, v25, v25 row_half_mirror row_mask:0xf bank_mask:0xa
    s_nop 1
    v_add_f32_dpp v24, v24, v24 quad_perm:[2,3,0,1] row_mask:0xf bank_mask:0xf
    s_nop 1
    v_add_f32_dpp v24, v24, v24 quad_perm:[1,0,3,2] row_mask:0xf bank_mask:0xf
    v_cvt_pk_bf16_f32 v36, v24, v24
    v_and_b32 v36, 0xffff0000, v36
    v_mul_f32 v36, 0x3db504f3, v36
    v_cvt_pk_bf16_f32 v36, v36, v36
    v_and_b32 v26, 0xffff0000, v36
    v_cmp_gt_f32 vcc, v26, v35
    s_nop 1
    s_cbranch_vccnz L_upd_20
L_back_21:
    v_sub_f32 v36, v26, v35
    v_mul_f32 v36, 0x3fb8aa3b, v36
    v_exp_f32 v36, v36
    s_nop 0
    v_fmac_f32 v33, 0.5, v36
    v_cvt_pk_bf16_f32 v32, v36, v36
    s_nop 1
    v_and_b32_dpp v12, v32, v8 row_newbcast:0 row_mask:0xf bank_mask:0xf
    v_and_b32_dpp v13, v32, v9 row_newbcast:0 row_mask:0xf bank_mask:0xf
    v_and_b32_dpp v14, v32, v10 row_newbcast:0 row_mask:0xf bank_mask:0xf
    v_and_b32_dpp v15, v32, v11 row_newbcast:0 row_mask:0xf bank_mask:0xf
    s_waitcnt vmcnt(3)
    s_nop 0
    v_mfma_f32_16x16x32_bf16 v[20:23], v[12:15], v[80:83], v[20:23]
    v_and_b32_dpp v16, v32, v8 row_newbcast:4 row_mask:0xf bank_mask:0xf
    v_and_b32_dpp v17, v32, v9 row_newbcast:4 row_mask:0xf bank_mask:0xf
    v_and_b32_dpp v18, v32, v10 row_newbcast:4 row_mask:0xf bank_mask:0xf
    v_and_b32_dpp v19, v32, v11 row_newbcast:4 row_mask:0xf bank_mask:0xf
    s_waitcnt vmcnt(2)
    s_nop 0
    v_mfma_f32_16x16x32_bf16 v[20:23], v[16:19], v[84:87], v[20:23]
    v_and_b32_dpp v12, v32, v8 row_newbcast:8 row_mask:0xf bank_mask:0xf
    v_and_b32_dpp v13, v32, v9 row_newbcast:8 row_mask:0xf bank_mask:0xf
    v_and_b32_dpp v14, v32, v10 row_newbcast:8 row_mask:0xf bank_mask:0xf
    v_and_b32_dpp v15, v32, v11 row_newbcast:8 row_mask:0xf bank_mask:0xf
    s_waitcnt vmcnt(1)
    s_nop 0
    v_mfma_f32_16x16x32_bf16 v[20:23], v[12:15], v[88:91], v[20:23]
    v_and_b32_dpp v16, v32, v8 row_newbcast:12 row_mask:0xf bank_mask:0xf
    v_and_b32_dpp v17, v32, v9 row_newbcast:12 row_mask:0xf bank_mask:0xf
    v_and_b32_dpp v18, v32, v10 row_newbcast:12 row_mask:0xf bank_mask:0xf
    v_and_b32_dpp v19, v32, v11 row_newbcast:12 row_mask:0xf bank_mask:0xf
    s_waitcnt vmcnt(0)
    s_nop 0
    v_mfma_f32_16x16x32_bf16 v[20:23], v[16:19], v[92:95], v[20:23]
    s_branch L_streamdone
L_dyn_7:
    s_sub_u32 s32, s22, 96
    s_min_u32 s32, s32, 383
    s_lshl_b32 s32, s32, 2
    v_mov_b32 v39, s32
    s_mov_b32 s34, 0
L_spin_9:
    ds_read_b32 v38, v39 offset:512
    s_waitcnt lgkmcnt(0)
    v_readfirstlane_b32 s22, v38
    s_nop 0
    s_cmp_lg_u32 s22, -1
    s_cbranch_scc1 L_spin_9_ok
    s_add_u32 s34, s34, 1
    s_cmp_lt_u32 s34, 0x100000
    s_cbranch_scc1 L_spin_9
    s_mov_b32 s22, 0x800000
L_spin_9_ok:
    s_cmp_ge_u32 s22, 0x800000
    s_cbranch_scc1 L_last
    s_bitcmp1_b32 s22, 0
    s_bitset0_b32 s22, 0
    s_cbranch_scc1 L_trans
    s_branch L_have_8
L_dyn_12:
    s_sub_u32 s32, s22, 96
    s_min_u32 s32, s32, 383
    s_lshl_b32 s32, s32, 2
    v_mov_b32 v39, s32
    s_mov_b32 s34, 0
L_spin_14:
    ds_read_b32 v38, v39 offset:512
    s_waitcnt lgkmcnt(0)
    v_readfirstlane_b32 s22, v38
    s_nop 0
    s_cmp_lg_u32 s22, -1
    s_cbranch_scc1 L_spin_14_ok
    s_add_u32 s34, s34, 1
    s_cmp_lt_u32 s34, 0x100000
    s_cbranch_scc1 L_spin_14
    s_mov_b32 s22, 0x800000
L_spin_14_ok:
    s_cmp_ge_u32 s22, 0x800000
    s_cbranch_scc1 L_last
    s_bitcmp1_b32 s22, 0
    s_bitset0_b32 s22, 0
    s_cbranch_scc1 L_trans
    s_branch L_have_13
L_dyn_17:
    s_sub_u32 s32, s22, 96
    s_min_u32 s32, s32, 383
    s_lshl_b32 s32, s32, 2
    v_mov_b32 v39, s32
    s_mov_b32 s34, 0
L_spin_19:
    ds_read_b32 v38, v39 offset:512
    s_waitcnt lgkmcnt(0)
    v_readfirstlane_b32 s22, v38
    s_nop 0
    s_cmp_lg_u32 s22, -1
    s_cbranch_scc1 L_spin_19_ok
    s_add_u32 s34, s34, 1
    s_cmp_lt_u32 s34, 0x100000
    s_cbranch_scc1 L_spin_19
    s_mov_b32 s22, 0x800000
L_spin_19_ok:
    s_cmp_ge_u32 s22, 0x800000
    s_cbranch_scc1 L_hlast
    s_bitcmp1_b32 s22, 0
    s_bitset0_b32 s22, 0
    s_branch L_have_18
L_upd_1:
    v_max_f32 v37, v26, v35
    s_nop 1
    v_max_f32_dpp v37, v37, v37 quad_perm:[1,0,3,2] row_mask:0xf bank_mask:0xf
    s_nop 1
    v_max_f32_dpp v37, v37, v37 quad_perm:[2,3,0,1] row_mask:0xf bank_mask:0xf
    s_nop 1
    v_max_f32_dpp v37, v37, v37 row_half_mirror row_mask:0xf bank_mask:0xf
    s_nop 1
    v_max_f32_dpp v37, v37, v37 row_mirror row_mask:0xf bank_mask:0xf
    s_nop 0
    v_readlane_b32 s32, v37, 0
    v_readlane_b32 s33, v37, 16
    v_readlane_b32 s34, v37, 32
    v_readlane_b32 s35, v37, 48
    s_nop 1
    v_mov_b32 v37, s32
    v_max_f32 v37, s33, v37
    v_max_f32 v37, s34, v37
    v_max_f32 v37, s35, v37
    v_sub_f32 v38, v35, v37
    v_mul_f32 v38, 0x3fb8aa3b, v38
    v_exp_f32 v38, v38
    v_mov_b32 v35, v37
    v_mul_f32 v33, v33, v38
    v_mul_f32 v20, v20, v38
    v_mul_f32 v21, v21, v38
    v_mul_f32 v22, v22, v38
    v_mul_f32 v23, v23, v38
    s_branch L_back_2
L_upd_3:
    v_max_f32 v37, v26, v35
    s_nop 1
    v_max_f32_dpp v37, v37, v37 quad_perm:[1,0,3,2] row_mask:0xf bank_mask:0xf
    s_nop 1
    v_max_f32_dpp v37, v37, v37 quad_perm:[2,3,0,1] row_mask:0xf bank_mask:0xf
    s_nop 1
    v_max_f32_dpp v37, v37, v37 row_half_mirror row_mask:0xf bank_mask:0xf
    s_nop 1
    v_max_f32_dpp v37, v37, v37 row_mirror row_mask:0xf bank_mask:0xf
    s_nop 0
    v_readlane_b32 s32, v37, 0
    v_readlane_b32 s33, v37, 16
    v_readlane_b32 s34, v37, 32
    v_readlane_b32 s35, v37, 48
    s_nop 1
    v_mov_b32 v37, s32
    v_max_f32 v37, s33, v37
    v_max_f32 v37, s34, v37
    v_max_f32 v37, s35, v37
    v_sub_f32 v38, v35, v37
    v_mul_f32 v38, 0x3fb8aa3b, v38
    v_exp_f32 v38, v38
    v_mov_b32 v35, v37
    v_mul_f32 v33, v33, v38
    v_mul_f32 v20, v20, v38
    v_mul_f32 v21, v21, v38
    v_mul_f32 v22, v22, v38
    v_mul_f32 v23, v23, v38
    s_branch L_back_4
L_upd_5:
    v_max_f32 v37, v26, v35
    s_nop 1
    v_max_f32_dpp v37, v37, v37 quad_perm:[1,0,3,2] row_mask:0xf bank_mask:0xf
    s_nop 1
    v_max_f32_dpp v37, v37, v37 quad_perm:[2,3,0,1] row_mask:0xf bank_mask:0xf
    s_nop 1
    v_max_f32_dpp v37, v37, v37 row_half_mirror row_mask:0xf bank_mask:0xf
    s_nop 1
    v_max_f32_dpp v37, v37, v37 row_mirror row_mask:0xf bank_mask:0xf
    s_nop 0
    v_readlane_b32 s32, v37, 0
    v_readlane_b32 s33, v37, 16
    v_readlane_b32 s34, v37, 32
    v_readlane_b32 s35, v37, 48
    s_nop 1
    v_mov_b32 v37, s32
    v_max_f32 v37, s33, v37
    v_max_f32 v37, s34, v37
    v_max_f32 v37, s35, v37
    v_sub_f32 v38, v35, v37
    v_mul_f32 v38, 0x3fb8aa3b, v38
    v_exp_f32 v38, v38
    v_mov_b32 v35, v37
    v_mul_f32 v33, v33, v38
    v_mul_f32 v20, v20, v38
    v_mul_f32 v21, v21, v38
    v_mul_f32 v22, v22, v38
    v_mul_f32 v23, v23, v38
    s_branch L_back_6
L_upd_10:
    v_max_f32 v37, v26, v35
    s_nop 1
    v_max_f32_dpp v37, v37, v37 quad_perm:[1,0,3,2] row_mask:0xf bank_mask:0xf
    s_nop 1
    v_max_f32_dpp v37, v37, v37 quad_perm:[2,3,0,1] row_mask:0xf bank_mask:0xf
    s_nop 1
    v_max_f32_dpp v37, v37, v37 row_half_mirror row_mask:0xf bank_mask:0xf
    s_nop 1
    v_max_f32_dpp v37, v37, v37 row_mirror row_mask:0xf bank_mask:0xf
    s_nop 0
    v_readlane_b32 s32, v37, 0
    v_readlane_b32 s33, v37, 16
    v_readlane_b32 s34, v37, 32
    v_readlane_b32 s35, v37, 48
    s_nop 1
    v_mov_b32 v37, s32
    v_max_f32 v37, s33, v37
    v_max_f32 v37, s34, v37
    v_max_f32 v37, s35, v37
    v_sub_f32 v38, v35, v37
    v_mul_f32 v38, 0x3fb8aa3b, v38
    v_exp_f32 v38, v38
    v_mov_b32 v35, v37
    v_mul_f32 v33, v33, v38
    v_mul_f32 v20, v20, v38
    v_mul_f32 v21, v21, v38
    v_mul_f32 v22, v22, v38
    v_mul_f32 v23, v23, v38
    s_branch L_back_11
L_upd_15:
    v_max_f32 v37, v26, v35
    s_nop 1
    v_max_f32_dpp v37, v37, v37 quad_perm:[1,0,3,2] row_mask:0xf bank_mask:0xf
    s_nop 1
    v_max_f32_dpp v37, v37, v37 quad_perm:[2,3,0,1] row_mask:0xf bank_mask:0xf
    s_nop 1
    v_max_f32_dpp v37, v37, v37 row_half_mirror row_mask:0xf bank_mask:0xf
    s_nop 1
    v_max_f32_dpp v37, v37, v37 row_mirror row_mask:0xf bank_mask:0xf
    s_nop 0
    v_readlane_b32 s32, v37, 0
    v_readlane_b32 s33, v37, 16
    v_readlane_b32 s34, v37, 32
    v_readlane_b32 s35, v37, 48
    s_nop 1
    v_mov_b32 v37, s32
    v_max_f32 v37, s33, v37
    v_max_f32 v37, s34, v37
    v_max_f32 v37, s35, v37
    v_sub_f32 v38, v35, v37
    v_mul_f32 v38, 0x3fb8aa3b, v38
    v_exp_f32 v38, v38
    v_mov_b32 v35, v37
    v_mul_f32 v33, v33, v38
    v_mul_f32 v20, v20, v38
    v_mul_f32 v21, v21, v38
    v_mul_f32 v22, v22, v38
    v_mul_f32 v23, v23, v38
    s_branch L_back_16
L_upd_20:
    v_max_f32 v37, v26, v35
    s_nop 1
    v_max_f32_dpp v37, v37, v37 quad_perm:[1,0,3,2] row_mask:0xf bank_mask:0xf
    s_nop 1
    v_max_f32_dpp v37, v37, v37 quad_perm:[2,3,0,1] row_mask:0xf bank_mask:0xf
    s_nop 1
    v_max_f32_dpp v37, v37, v37 row_half_mirror row_mask:0xf bank_mask:0xf
    s_nop 1
    v_max_f32_dpp v37, v37, v37 row_mirror row_mask:0xf bank_mask:0xf
    s_nop 0
    v_readlane_b32 s32, v37, 0
    v_readlane_b32 s33, v37, 16
    v_readlane_b32 s34, v37, 32
    v_readlane_b32 s35, v37, 48
    s_nop 1
    v_mov_b32 v37, s32
    v_max_f32 v37, s33, v37
    v_max_f32 v37, s34, v37
    v_max_f32 v37, s35, v37
    v_sub_f32 v38, v35, v37
    v_mul_f32 v38, 0x3fb8aa3b, v38
    v_exp_f32 v38, v38
    v_mov_b32 v35, v37
    v_mul_f32 v33, v33, v38
    v_mul_f32 v20, v20, v38
    v_mul_f32 v21, v21, v38
    v_mul_f32 v22, v22, v38
    v_mul_f32 v23, v23, v38
    s_branch L_back_21
L_streamdone:
    s_cmp_lg_u32 s51, 1
    s_cbranch_scc1 L_pfm_ok
    s_mov_b32 s48, 0
L_pfm:
    ds_read_b32 v45, v42 offset:4
    s_waitcnt lgkmcnt(0)
    v_readfirstlane_b32 s46, v45
    s_nop 0
    s_cmp_ge_u32 s46, 8
    s_cbranch_scc1 L_pfm_ok
    s_add_u32 s48, s48, 1
    s_cmp_lt_u32 s48, 0x100000
    s_cbranch_scc1 L_pfm
L_pfm_ok:
    s_cmp_eq_u32 s51, 1
    s_cbranch_scc1 L_stg1a
    s_branch L_stgda
L_stg1a:
    v_lshrrev_b32 v44, 3, v0
    v_lshlrev_b32 v44, 10, v44
    v_and_b32 v45, 7, v0
    v_lshlrev_b32 v45, 4, v45
    v_add_u32 v44, v44, v45
    s_mov_b32 s12, s64
    s_mov_b32 s13, s65
    s_mov_b32 s14, 0x400000
    s_mov_b32 s15, 0x20000
    s_lshl_b32 s46, s4, 19
    s_lshl_b32 s48, s50, 7
    s_add_u32 s46, s46, s48
    s_lshl_b32 s48, s3, 16
    s_add_u32 s46, s46, s48
    s_lshl_b32 s48, s3, 13
    s_add_u32 m0, s48, 25600
    s_add_u32 s48, s46, 0
    buffer_load_dwordx4 v44, s[12:15], s48 offen nt lds
    s_lshl_b32 s48, s3, 13
    s_add_u32 m0, s48, 26624
    s_add_u32 s48, s46, 8192
    buffer_load_dwordx4 v44, s[12:15], s48 offen nt lds
    s_lshl_b32 s48, s3, 13
    s_add_u32 m0, s48, 27648
    s_add_u32 s48, s46, 16384
    buffer_load_dwordx4 v44, s[12:15], s48 offen nt lds
    s_lshl_b32 s48, s3, 13
    s_add_u32 m0, s48, 28672
    s_add_u32 s48, s46, 24576
    buffer_load_dwordx4 v44, s[12:15], s48 offen nt lds
    s_lshl_b32 s48, s3, 13
    s_add_u32 m0, s48, 29696
    s_add_u32 s48, s46, 32768
    buffer_load_dwordx4 v44, s[12:15], s48 offen nt lds
    s_lshl_b32 s48, s3, 13
    s_add_u32 m0, s48, 30720
    s_add_u32 s48, s46, 40960
    buffer_load_dwordx4 v44, s[12:15], s48 offen nt lds
    s_lshl_b32 s48, s3, 13
    s_add_u32 m0, s48, 31744
    s_add_u32 s48, s46, 49152
    buffer_load_dwordx4 v44, s[12:15], s48 offen nt lds
    s_lshl_b32 s48, s3, 13
    s_add_u32 m0, s48, 32768
    s_add_u32 s48, s46, 57344
    buffer_load_dwordx4 v44, s[12:15], s48 offen nt lds
    s_branch L_stgda
L_stgda:
    s_nop 1
    v_add_f32_dpp v33, v33, v33 quad_perm:[1,0,3,2] row_mask:0xf bank_mask:0xf
    s_nop 1
    v_add_f32_dpp v33, v33, v33 quad_perm:[2,3,0,1] row_mask:0xf bank_mask:0xf
    s_nop 1
    v_add_f32_dpp v33, v33, v33 row_half_mirror row_mask:0xf bank_mask:0xf
    s_nop 1
    v_add_f32_dpp v33, v33, v33 row_mirror row_mask:0xf bank_mask:0xf
    s_nop 0
    v_readlane_b32 s32, v33, 0
    v_readlane_b32 s33, v33, 16
    v_readlane_b32 s34, v33, 32
    v_readlane_b32 s35, v33, 48
    s_nop 1
    v_mov_b32 v33, s32
    v_add_f32 v33, s33, v33
    v_add_f32 v33, s34, v33
    v_add_f32 v33, s35, v33
    v_mul_f32 v37, 0.5, v33
    v_mov_b32 v36, v35
    v_and_b32 v2, 15, v0
    v_lshlrev_b32 v2, 5, v2
    v_lshrrev_b32 v38, 4, v0
    v_lshlrev_b32 v38, 4, v38
    v_add_u32 v2, v2, v38
    s_lshl_b32 s44, s3, 9
    v_add_u32 v2, s44, v2
    s_mov_b32 exec_hi, 0
    ds_write_b128 v2, v[20:23] offset:3072
    s_lshl_b32 s44, s3, 3
    v_mov_b32 v2, s44
    s_mov_b64 exec, 1
    ds_write_b64 v2, v[36:37] offset:64
    s_mov_b64 exec, -1
    s_waitcnt lgkmcnt(0)
    s_barrier
    s_cmp_lg_u32 s3, 0
    s_cbranch_scc1 L_nomerge
    s_setprio 3
    v_lshlrev_b32 v2, 3, v0
    v_and_b32 v5, 7, v0
    v_lshlrev_b32 v5, 3, v5
    ds_read_b64 v[104:105], v5 offset:64
    ds_read_b64 v[88:89], v2 offset:3072
    ds_read_b64 v[90:91], v2 offset:3584
    ds_read_b64 v[92:93], v2 offset:4096
    ds_read_b64 v[94:95], v2 offset:4608
    ds_read_b64 v[96:97], v2 offset:5120
    ds_read_b64 v[98:99], v2 offset:5632
    ds_read_b64 v[100:101], v2 offset:6144
    ds_read_b64 v[102:103], v2 offset:6656
    v_mov_b32 v13, s80
    v_mov_b32 v15, s80
    v_mov_b32 v17, s80
    v_mov_b32 v19, s80
    s_lshl_b32 s44, s2, 11
    s_add_u32 s44, s44, 0x80000
    s_waitcnt lgkmcnt(8)
    v_max_f32_dpp v16, v104, v104 quad_perm:[1,0,3,2] row_mask:0xf bank_mask:0xf
    s_nop 1
    v_max_f32_dpp v16, v16, v16 quad_perm:[2,3,0,1] row_mask:0xf bank_mask:0xf
    s_nop 1
    v_max_f32_dpp v16, v16, v16 row_half_mirror row_mask:0xf bank_mask:0xf
    v_sub_f32 v6, v104, v16
    v_mul_f32 v6, 0x3fb8aa3b, v6
    v_exp_f32 v6, v6
    s_nop 0
    v_mul_f32 v18, v6, v105
    s_waitcnt lgkmcnt(0)
    v_mul_f32_dpp v12, v6, v88 row_newbcast:0 row_mask:0xf bank_mask:0xf
    v_mul_f32_dpp v14, v6, v89 row_newbcast:0 row_mask:0xf bank_mask:0xf
    v_add_f32_dpp v18, v18, v18 quad_perm:[1,0,3,2] row_mask:0xf bank_mask:0xf
    v_mul_f32_dpp v20, v6, v90 row_newbcast:1 row_mask:0xf bank_mask:0xf
    v_mul_f32_dpp v21, v6, v91 row_newbcast:1 row_mask:0xf bank_mask:0xf
    v_fmac_f32_dpp v12, v6, v92 row_newbcast:2 row_mask:0xf bank_mask:0xf
    v_fmac_f32_dpp v14, v6, v93 row_newbcast:2 row_mask:0xf bank_mask:0xf
    v_add_f32_dpp v18, v18, v18 quad_perm:[2,3,0,1] row_mask:0xf bank_mask:0xf
    v_fmac_f32_dpp v20, v6, v94 row_newbcast:3 row_mask:0xf bank_mask:0xf
    v_fmac_f32_dpp v21, v6, v95 row_newbcast:3 row_mask:0xf bank_mask:0xf
    v_fmac_f32_dpp v12, v6, v96 row_newbcast:4 row_mask:0xf bank_mask:0xf
    v_fmac_f32_dpp v14, v6, v97 row_newbcast:4 row_mask:0xf bank_mask:0xf
    v_add_f32_dpp v18, v18, v18 row_half_mirror row_mask:0xf bank_mask:0xf
    v_fmac_f32_dpp v20, v6, v98 row_newbcast:5 row_mask:0xf bank_mask:0xf
    v_fmac_f32_dpp v21, v6, v99 row_newbcast:5 row_mask:0xf bank_mask:0xf
    v_fmac_f32_dpp v12, v6, v100 row_newbcast:6 row_mask:0xf bank_mask:0xf
    v_fmac_f32_dpp v14, v6, v101 row_newbcast:6 row_mask:0xf bank_mask:0xf
    v_fmac_f32_dpp v20, v6, v102 row_newbcast:7 row_mask:0xf bank_mask:0xf
    v_fmac_f32_dpp v21, v6, v103 row_newbcast:7 row_mask:0xf bank_mask:0xf
    v_add_f32 v12, v12, v20
    v_add_f32 v14, v14, v21
    buffer_store_dwordx4 v[12:15], v1, s[16:19], s44 offen sc1
    s_mov_b64 exec, 1
    buffer_store_dwordx4 v[16:19], off, s[16:19], s44 offset:1024 sc1
    s_mov_b64 exec, -1
    s_setprio 0
L_nomerge:
    s_cmp_eq_u32 s51, 2
    s_cbranch_scc1 L_stg2b
    s_cmp_eq_u32 s51, 3
    s_cbranch_scc1 L_stg3b
    s_branch L_stgdb
L_stg2b:
    v_lshrrev_b32 v44, 2, v0
    v_mul_u32_u24 v44, 2752, v44
    v_and_b32 v45, 3, v0
    v_lshlrev_b32 v45, 4, v45
    v_add_u32 v44, v44, v45
    s_mul_i32 s46, s3, 176128
    s_lshl_b32 s48, s50, 6
    s_add_u32 s46, s46, s48
    s_mov_b32 s12, s68
    s_mov_b32 s13, s69
    s_mov_b32 s14, 0x158000
    s_mov_b32 s15, 0x20000
    s_lshl_b32 s48, s3, 12
    s_add_u32 m0, s48, 25600
    s_add_u32 s48, s46, 0
    buffer_load_dwordx4 v44, s[12:15], s48 offen nt lds
    s_lshl_b32 s48, s3, 12
    s_add_u32 m0, s48, 26624
    s_add_u32 s48, s46, 44032
    buffer_load_dwordx4 v44, s[12:15], s48 offen nt lds
    s_lshl_b32 s48, s3, 12
    s_add_u32 m0, s48, 27648
    s_add_u32 s48, s46, 88064
    buffer_load_dwordx4 v44, s[12:15], s48 offen nt lds
    s_lshl_b32 s48, s3, 12
    s_add_u32 m0, s48, 28672
    s_add_u32 s48, s46, 132096
    buffer_load_dwordx4 v44, s[12:15], s48 offen nt lds
    s_mov_b32 s12, s70
    s_mov_b32 s13, s71
    s_mov_b32 s14, 0x158000
    s_mov_b32 s15, 0x20000
    s_lshl_b32 s48, s3, 12
    s_add_u32 m0, s48, 58368
    s_add_u32 s48, s46, 0
    buffer_load_dwordx4 v44, s[12:15], s48 offen nt lds
    s_lshl_b32 s48, s3, 12
    s_add_u32 m0, s48, 59392
    s_add_u32 s48, s46, 44032
    buffer_load_dwordx4 v44, s[12:15], s48 offen nt lds
    s_lshl_b32 s48, s3, 12
    s_add_u32 m0, s48, 60416
    s_add_u32 s48, s46, 88064
    buffer_load_dwordx4 v44, s[12:15], s48 offen nt lds
    s_lshl_b32 s48, s3, 12
    s_add_u32 m0, s48, 61440
    s_add_u32 s48, s46, 132096
    buffer_load_dwordx4 v44, s[12:15], s48 offen nt lds
    s_branch L_stgdb
L_stg3b:
    v_lshrrev_b32 v44, 2, v0
    v_lshlrev_b32 v44, 10, v44
    v_and_b32 v45, 3, v0
    v_lshlrev_b32 v45, 4, v45
    v_add_u32 v44, v44, v45
    s_mov_b32 s12, s72
    s_mov_b32 s13, s73
    s_mov_b32 s14, 0x158000
    s_mov_b32 s15, 0x20000
    s_lshl_b32 s46, s50, 6
    s_lshl_b32 s48, s3, 15
    s_add_u32 s46, s46, s48
    s_lshl_b32 s48, s3, 11
    s_add_u32 m0, s48, 25600
    s_add_u32 s48, s46, 0
    buffer_load_dwordx4 v44, s[12:15], s48 offen nt lds
    s_lshl_b32 s48, s3, 11
    s_add_u32 m0, s48, 26624
    s_add_u32 s48, s46, 16384
    buffer_load_dwordx4 v44, s[12:15], s48 offen nt lds
    s_lshl_b32 s48, s3, 11
    s_add_u32 m0, s48, 41984
    s_add_u32 s48, s46, 262144
    buffer_load_dwordx4 v44, s[12:15], s48 offen nt lds
    s_lshl_b32 s48, s3, 11
    s_add_u32 m0, s48, 43008
    s_add_u32 s48, s46, 278528
    buffer_load_dwordx4 v44, s[12:15], s48 offen nt lds
    s_lshl_b32 s48, s3, 11
    s_add_u32 m0, s48, 58368
    s_add_u32 s48, s46, 524288
    buffer_load_dwordx4 v44, s[12:15], s48 offen nt lds
    s_lshl_b32 s48, s3, 11
    s_add_u32 m0, s48, 59392
    s_add_u32 s48, s46, 540672
    buffer_load_dwordx4 v44, s[12:15], s48 offen nt lds
    s_lshl_b32 s48, s3, 11
    s_add_u32 m0, s48, 74752
    s_add_u32 s48, s46, 786432
    buffer_load_dwordx4 v44, s[12:15], s48 offen nt lds
    s_lshl_b32 s48, s3, 11
    s_add_u32 m0, s48, 75776
    s_add_u32 s48, s46, 802816
    buffer_load_dwordx4 v44, s[12:15], s48 offen nt lds
    s_lshl_b32 s48, s3, 11
    s_add_u32 m0, s48, 91136
    s_add_u32 s48, s46, 1048576
    buffer_load_dwordx4 v44, s[12:15], s48 offen nt lds
    s_lshl_b32 s48, s3, 11
    s_add_u32 m0, s48, 92160
    s_add_u32 s48, s46, 1064960
    buffer_load_dwordx4 v44, s[12:15], s48 offen nt lds
    s_cmp_gt_u32 s3, 2
    s_cbranch_scc1 L_stgdb
    s_lshl_b32 s48, s3, 11
    s_add_u32 m0, s48, 107520
    s_add_u32 s48, s46, 1310720
    buffer_load_dwordx4 v44, s[12:15], s48 offen nt lds
    s_lshl_b32 s48, s3, 11
    s_add_u32 m0, s48, 108544
    s_add_u32 s48, s46, 1327104
    buffer_load_dwordx4 v44, s[12:15], s48 offen nt lds
L_stgdb:
    s_cmp_eq_u32 s51, 2
    s_cbranch_scc1 L_ffn1
    s_cmp_eq_u32 s51, 3
    s_cbranch_scc1 L_ffn2
    s_cmp_eq_u32 s51, 0
    s_cbranch_scc1 L_fin
    v_and_b32 v9, 31, v0
    v_lshrrev_b32 v11, 5, v0
    s_lshl_b32 s44, s3, 7
    v_lshlrev_b32 v10, 2, v9
    v_add_u32 v10, s44, v10
    v_lshrrev_b32 v20, 4, v0
    v_lshlrev_b32 v20, 4, v20
    v_add_u32 v20, s44, v20
    v_lshlrev_b32 v21, 2, v0
    s_lshl_b32 s44, s3, 8
    v_add_u32 v21, s44, v21
    v_lshrrev_b32 v7, 4, v0
    v_lshlrev_b32 v7, 10, v7
    v_bfe_u32 v47, v0, 2, 2
    v_lshlrev_b32 v47, 7, v47
    v_add_u32 v7, v7, v47
    v_and_b32 v47, 3, v0
    v_lshlrev_b32 v47, 3, v47
    v_add_u32 v7, v7, v47
    s_lshl_b32 s44, s3, 13
    s_add_u32 s44, s44, 25600
    v_add_u32 v7, s44, v7
    s_and_b32 s44, s3, 1
    s_lshl_b32 s44, s44, 9
    v_lshlrev_b32 v12, 11, v11
    v_lshlrev_b32 v13, 4, v9
    v_add_u32 v12, v12, v13
    v_add_u32 v12, s44, v12
    s_lshl_b32 s45, s4, 2
    s_lshr_b32 s46, s3, 1
    s_add_u32 s45, s45, s46
    s_lshl_b32 s45, s45, 14
    s_add_u32 s45, s45, 0x80000
    s_add_u32 s46, s45, 4096
    s_add_u32 s48, s45, 8192
    s_add_u32 s49, s45, 12288
    v_and_b32 v13, 7, v0
    v_xor_b32 v13, v13, v11
    v_lshlrev_b32 v13, 11, v13
    s_mov_b32 s40, 0
    buffer_load_dwordx4 v[88:91], v12, s[16:19], s45 offen offset:0 sc1
    buffer_load_dwordx4 v[92:95], v12, s[16:19], s46 offen offset:0 sc1
    buffer_load_dwordx4 v[96:99], v12, s[16:19], s48 offen offset:0 sc1
    buffer_load_dwordx4 v[100:103], v12, s[16:19], s49 offen offset:0 sc1
    buffer_load_dwordx4 v[104:107], v13, s[16:19], s45 offen offset:1024 sc1
    s_waitcnt vmcnt(0)
    ds_read_b64_tr_b16 v[48:49], v7 offset:0
    ds_read_b64_tr_b16 v[50:51], v7 offset:512
    ds_read_b64_tr_b16 v[52:53], v7 offset:32
    ds_read_b64_tr_b16 v[54:55], v7 offset:544
    ds_read_b64_tr_b16 v[56:57], v7 offset:64
    ds_read_b64_tr_b16 v[58:59], v7 offset:576
    ds_read_b64_tr_b16 v[60:61], v7 offset:96
    ds_read_b64_tr_b16 v[62:63], v7 offset:608
    ds_read_b64_tr_b16 v[64:65], v7 offset:4096
    ds_read_b64_tr_b16 v[66:67], v7 offset:4608
    ds_read_b64_tr_b16 v[68:69], v7 offset:4128
    ds_read_b64_tr_b16 v[70:71], v7 offset:4640
    ds_read_b64_tr_b16 v[72:73], v7 offset:4160
    ds_read_b64_tr_b16 v[74:75], v7 offset:4672
    ds_read_b64_tr_b16 v[76:77], v7 offset:4192
    ds_read_b64_tr_b16 v[78:79], v7 offset:4704
    s_branch L_pollA_22_chk
L_pollA_22:
    buffer_load_dwordx4 v[88:91], v12, s[16:19], s45 offen offset:0 sc1
    buffer_load_dwordx4 v[92:95], v12, s[16:19], s46 offen offset:0 sc1
    buffer_load_dwordx4 v[96:99], v12, s[16:19], s48 offen offset:0 sc1
    buffer_load_dwordx4 v[100:103], v12, s[16:19], s49 offen offset:0 sc1
    buffer_load_dwordx4 v[104:107], v13, s[16:19], s45 offen offset:1024 sc1
    s_waitcnt vmcnt(0)
L_pollA_22_chk:
    v_xor_b32 v140, s80, v89
    v_xor_b32 v141, s80, v91
    v_bitop3_b32 v140, v93, s80, v140 bitop3:0xbe
    v_bitop3_b32 v141, v95, s80, v141 bitop3:0xbe
    v_bitop3_b32 v140, v97, s80, v140 bitop3:0xbe
    v_bitop3_b32 v141, v99, s80, v141 bitop3:0xbe
    v_bitop3_b32 v140, v101, s80, v140 bitop3:0xbe
    v_bitop3_b32 v141, v103, s80, v141 bitop3:0xbe
    v_bitop3_b32 v140, v105, s80, v140 bitop3:0xbe
    v_bitop3_b32 v141, v107, s80, v141 bitop3:0xbe
    v_or_b32 v140, v140, v141
    v_cmp_eq_u32 s[42:43], 0, v140
    s_nop 0
    s_cmp_eq_u64 s[42:43], exec
    s_cbranch_scc1 L_okA_23
    s_add_u32 s40, s40, 1
    s_cmp_lt_u32 s40, 200000
    s_cbranch_scc1 L_pollA_22
L_okA_23:
    v_mov_b32 v14, v104
    s_nop 1
    v_max_f32_dpp v14, v14, v14 quad_perm:[1,0,3,2] row_mask:0xf bank_mask:0xf
    s_nop 1
    v_max_f32_dpp v14, v14, v14 quad_perm:[2,3,0,1] row_mask:0xf bank_mask:0xf
    s_nop 1
    v_max_f32_dpp v14, v14, v14 row_half_mirror row_mask:0xf bank_mask:0xf
    v_sub_f32 v14, v104, v14
    v_mul_f32 v14, 0x3fb8aa3b, v14
    v_exp_f32 v14, v14
    s_nop 0
    v_mul_f32 v15, v14, v106
    s_nop 1
    v_add_f32_dpp v15, v15, v15 quad_perm:[1,0,3,2] row_mask:0xf bank_mask:0xf
    s_nop 1
    v_add_f32_dpp v15, v15, v15 quad_perm:[2,3,0,1] row_mask:0xf bank_mask:0xf
    s_nop 1
    v_add_f32_dpp v15, v15, v15 row_half_mirror row_mask:0xf bank_mask:0xf
    v_rcp_f32 v15, v15
    s_nop 0
    v_mul_f32 v14, v14, v15
    s_nop 1
    v_mul_f32_dpp v16, v14, v88 row_newbcast:0 row_mask:0xf bank_mask:0xf
    v_mul_f32_dpp v17, v14, v90 row_newbcast:0 row_mask:0xf bank_mask:0xf
    v_mul_f32_dpp v18, v14, v92 row_newbcast:2 row_mask:0xf bank_mask:0xf
    v_mul_f32_dpp v19, v14, v94 row_newbcast:2 row_mask:0xf bank_mask:0xf
    v_fmac_f32_dpp v16, v14, v96 row_newbcast:4 row_mask:0xf bank_mask:0xf
    v_fmac_f32_dpp v17, v14, v98 row_newbcast:4 row_mask:0xf bank_mask:0xf
    v_fmac_f32_dpp v18, v14, v100 row_newbcast:6 row_mask:0xf bank_mask:0xf
    v_fmac_f32_dpp v19, v14, v102 row_newbcast:6 row_mask:0xf bank_mask:0xf
    v_add_f32 v16, v16, v18
    v_add_f32 v17, v17, v19
    v_mov_b32 v18, v16
    v_mov_b32 v19, v17
    s_nop 0
    v_permlane32_swap_b32 v16, v18
    v_permlane32_swap_b32 v17, v19
    v_add_f32 v16, v16, v18
    v_add_f32 v17, v17, v19
    v_cvt_pk_bf16_f32 v16, v16, v17
    ds_write_b32 v10, v16 offset:2048
    s_waitcnt lgkmcnt(0)
    ds_read_b128 v[24:27], v20 offset:2048
    ds_read_b128 v[28:31], v20 offset:2112
    s_waitcnt lgkmcnt(0)
    v_mfma_f32_16x16x32_bf16 v[104:107], v[24:27], v[48:51], 0
    v_mfma_f32_16x16x32_bf16 v[108:111], v[24:27], v[52:55], 0
    v_mfma_f32_16x16x32_bf16 v[112:115], v[24:27], v[56:59], 0
    v_mfma_f32_16x16x32_bf16 v[116:119], v[24:27], v[60:63], 0
    v_mfma_f32_16x16x32_bf16 v[104:107], v[28:31], v[64:67], v[104:107]
    v_mfma_f32_16x16x32_bf16 v[108:111], v[28:31], v[68:71], v[108:111]
    v_mfma_f32_16x16x32_bf16 v[112:115], v[28:31], v[72:75], v[112:115]
    v_mfma_f32_16x16x32_bf16 v[116:119], v[28:31], v[76:79], v[116:119]
    s_mov_b64 exec, 0xffff
    s_nop 3
    ds_write_b32 v21, v104 offset:7168
    ds_write_b32 v21, v108 offset:7232
    ds_write_b32 v21, v112 offset:7296
    ds_write_b32 v21, v116 offset:7360
    s_mov_b64 exec, -1
    s_waitcnt lgkmcnt(0)
    s_barrier
    s_cmp_lg_u32 s3, 0
    s_cbranch_scc1 L_fin
    v_lshlrev_b32 v22, 3, v0
    s_mov_b32 exec_hi, 0
    ds_read_b64 v[88:89], v22 offset:7168
    ds_read_b64 v[90:91], v22 offset:7424
    ds_read_b64 v[92:93], v22 offset:7680
    ds_read_b64 v[94:95], v22 offset:7936
    ds_read_b64 v[96:97], v22 offset:8192
    ds_read_b64 v[98:99], v22 offset:8448
    ds_read_b64 v[100:101], v22 offset:8704
    ds_read_b64 v[102:103], v22 offset:8960
    v_mov_b32 v13, s80
    v_mov_b32 v15, s80
    s_lshl_b32 s44, s4, 12
    s_mul_i32 s45, s50, 512
    s_add_u32 s44, s44, s45
    s_add_u32 s44, s44, 0x100000
    s_waitcnt lgkmcnt(0)
    v_add_f32 v88, v88, v90
    v_add_f32 v89, v89, v91
    v_add_f32 v92, v92, v94
    v_add_f32 v93, v93, v95
    v_add_f32 v96, v96, v98
    v_add_f32 v97, v97, v99
    v_add_f32 v100, v100, v102
    v_add_f32 v101, v101, v103
    v_add_f32 v88, v88, v92
    v_add_f32 v89, v89, v93
    v_add_f32 v96, v96, v100
    v_add_f32 v97, v97, v101
    v_add_f32 v12, v88, v96
    v_add_f32 v14, v89, v97
    buffer_store_dwordx4 v[12:15], v1, s[16:19], s44 offen sc1
    s_mov_b64 exec, -1
    s_branch L_fin
L_ffn1:
    v_and_b32 v9, 31, v0
    v_lshrrev_b32 v11, 5, v0
    s_lshl_b32 s44, s3, 7
    v_lshlrev_b32 v10, 2, v9
    v_add_u32 v10, s44, v10
    v_lshrrev_b32 v20, 4, v0
    v_lshlrev_b32 v20, 4, v20
    v_add_u32 v20, s44, v20
    v_lshlrev_b32 v21, 2, v0
    s_lshl_b32 s44, s3, 8
    v_add_u32 v21, s44, v21
    s_mov_b32 s8, s56
    s_mov_b32 s9, s57
    s_mov_b32 s10, 0x400
    s_mov_b32 s11, 0x20000
    buffer_load_dword v41, v10, s[8:11], 0 offen
    v_lshrrev_b32 v8, 4, v0
    v_lshlrev_b32 v8, 9, v8
    v_bfe_u32 v47, v0, 2, 2
    v_lshlrev_b32 v47, 6, v47
    v_add_u32 v8, v8, v47
    v_and_b32 v47, 3, v0
    v_lshlrev_b32 v47, 3, v47
    v_add_u32 v8, v8, v47
    s_lshl_b32 s44, s3, 12
    s_add_u32 s44, s44, 25600
    v_add_u32 v8, s44, v8
    s_waitcnt vmcnt(0)
    ds_read_b64_tr_b16 v[48:49], v8 offset:0
    ds_read_b64_tr_b16 v[50:51], v8 offset:256
    ds_read_b64_tr_b16 v[52:53], v8 offset:2048
    ds_read_b64_tr_b16 v[54:55], v8 offset:2304
    ds_read_b64_tr_b16 v[56:57], v8 offset:32
    ds_read_b64_tr_b16 v[58:59], v8 offset:288
    ds_read_b64_tr_b16 v[60:61], v8 offset:2080
    ds_read_b64_tr_b16 v[62:63], v8 offset:2336
    ds_read_b64_tr_b16 v[64:65], v8 offset:32768
    ds_read_b64_tr_b16 v[66:67], v8 offset:33024
    ds_read_b64_tr_b16 v[68:69], v8 offset:34816
    ds_read_b64_tr_b16 v[70:71], v8 offset:35072
    ds_read_b64_tr_b16 v[72:73], v8 offset:32800
    ds_read_b64_tr_b16 v[74:75], v8 offset:33056
    ds_read_b64_tr_b16 v[76:77], v8 offset:34848
    ds_read_b64_tr_b16 v[78:79], v8 offset:35104
    v_mov_b32 v104, 0
    v_mov_b32 v105, 0
    v_mov_b32 v106, 0
    v_mov_b32 v107, 0
    v_mov_b32 v108, 0
    v_mov_b32 v109, 0
    v_mov_b32 v110, 0
    v_mov_b32 v111, 0
    v_mov_b32 v112, 0
    v_mov_b32 v113, 0
    v_mov_b32 v114, 0
    v_mov_b32 v115, 0
    v_mov_b32 v116, 0
    v_mov_b32 v117, 0
    v_mov_b32 v118, 0
    v_mov_b32 v119, 0
    v_mov_b32 v24, 0x3f803f80
    v_mov_b32 v25, 0x3f803f80
    v_mov_b32 v26, 0x3f803f80
    v_mov_b32 v27, 0x3f803f80
    s_waitcnt lgkmcnt(0)
    s_nop 0
    v_mfma_f32_16x16x32_bf16 v[104:107], v[24:27], v[48:51], v[104:107]
    v_mfma_f32_16x16x32_bf16 v[108:111], v[24:27], v[56:59], v[108:111]
    v_mfma_f32_16x16x32_bf16 v[112:115], v[24:27], v[64:67], v[112:115]
    v_mfma_f32_16x16x32_bf16 v[116:119], v[24:27], v[72:75], v[116:119]
    v_mfma_f32_16x16x32_bf16 v[104:107], v[24:27], v[52:55], v[104:107]
    v_mfma_f32_16x16x32_bf16 v[108:111], v[24:27], v[60:63], v[108:111]
    v_mfma_f32_16x16x32_bf16 v[112:115], v[24:27], v[68:71], v[112:115]
    v_mfma_f32_16x16x32_bf16 v[116:119], v[24:27], v[76:79], v[116:119]
    s_mov_b64 exec, 0xffff
    s_nop 3
    ds_write_b32 v21, v104 offset:9216
    ds_write_b32 v21, v108 offset:9280
    ds_write_b32 v21, v112 offset:9344
    ds_write_b32 v21, v116 offset:9408
    s_mov_b64 exec, -1
    s_waitcnt lgkmcnt(0)
    s_barrier
    v_lshlrev_b32 v22, 2, v0
    ds_read_b32 v88, v22 offset:9216
    ds_read_b32 v89, v22 offset:9472
    ds_read_b32 v90, v22 offset:9728
    ds_read_b32 v91, v22 offset:9984
    ds_read_b32 v92, v22 offset:10240
    ds_read_b32 v93, v22 offset:10496
    ds_read_b32 v94, v22 offset:10752
    ds_read_b32 v95, v22 offset:11008
    v_mov_b32 v104, 0
    v_mov_b32 v105, 0
    v_mov_b32 v106, 0
    v_mov_b32 v107, 0
    v_mov_b32 v108, 0
    v_mov_b32 v109, 0
    v_mov_b32 v110, 0
    v_mov_b32 v111, 0
    v_mov_b32 v112, 0
    v_mov_b32 v113, 0
    v_mov_b32 v114, 0
    v_mov_b32 v115, 0
    v_mov_b32 v116, 0
    v_mov_b32 v117, 0
    v_mov_b32 v118, 0
    v_mov_b32 v119, 0
    v_lshlrev_b32 v12, 12, v11
    v_lshlrev_b32 v13, 4, v9
    v_add_u32 v12, v12, v13
    s_lshl_b32 s44, s3, 9
    v_add_u32 v12, s44, v12
    s_mov_b32 s45, 0x100000
    s_mov_b32 s46, 0x102000
    s_mov_b32 s48, 0x104000
    s_mov_b32 s49, 0x106000
    s_waitcnt lgkmcnt(0)
    v_add_f32 v88, v88, v89
    v_add_f32 v90, v90, v91
    v_add_f32 v92, v92, v93
    v_add_f32 v94, v94, v95
    v_add_f32 v88, v88, v90
    v_add_f32 v92, v92, v94
    v_add_f32 v40, v88, v92
    v_lshlrev_b32 v26, 16, v41
    v_and_b32 v27, 0xffff0000, v41
    s_lshl_b32 s38, s50, 8
    s_add_u32 s38, s38, 0x110000
    s_lshl_b32 s44, s3, 3
    v_mov_b32 v39, s44
    v_and_b32 v38, 7, v0
    v_lshlrev_b32 v38, 3, v38
    s_mov_b32 s40, 0
L_pollB_24:
    buffer_load_dwordx4 v[88:91], v12, s[16:19], s45 offen offset:0 sc1
    buffer_load_dwordx4 v[92:95], v12, s[16:19], s46 offen offset:0 sc1
    buffer_load_dwordx4 v[96:99], v12, s[16:19], s48 offen offset:0 sc1
    buffer_load_dwordx4 v[100:103], v12, s[16:19], s49 offen offset:0 sc1
    s_waitcnt vmcnt(0)
    v_xor_b32 v140, s80, v89
    v_xor_b32 v141, s80, v91
    v_bitop3_b32 v140, v93, s80, v140 bitop3:0xbe
    v_bitop3_b32 v141, v95, s80, v141 bitop3:0xbe
    v_bitop3_b32 v140, v97, s80, v140 bitop3:0xbe
    v_bitop3_b32 v141, v99, s80, v141 bitop3:0xbe
    v_bitop3_b32 v140, v101, s80, v140 bitop3:0xbe
    v_bitop3_b32 v141, v103, s80, v141 bitop3:0xbe
    v_or_b32 v140, v140, v141
    v_cmp_eq_u32 s[42:43], 0, v140
    s_nop 0
    s_cmp_eq_u64 s[42:43], exec
    s_cbranch_scc1 L_okB_25
    s_add_u32 s40, s40, 1
    s_cmp_lt_u32 s40, 200000
    s_cbranch_scc1 L_pollB_24
L_okB_25:
    v_add_f32 v16, v88, v92
    v_add_f32 v17, v90, v94
    v_add_f32 v18, v96, v100
    v_add_f32 v19, v98, v102
    v_add_f32 v16, v16, v18
    v_add_f32 v17, v17, v19
    v_mov_b32 v18, v16
    v_mov_b32 v19, v17
    s_nop 0
    v_permlane32_swap_b32 v16, v18
    v_permlane32_swap_b32 v17, v19
    v_add_f32 v16, v16, v18
    v_add_f32 v17, v17, v19
    v_cvt_pk_bf16_f32 v16, v16, v17
    v_lshlrev_b32 v17, 16, v16
    v_and_b32 v18, 0xffff0000, v16
    v_add_f32 v17, v17, v26
    v_add_f32 v18, v18, v27
    v_cvt_pk_bf16_f32 v16, v17, v18
    ds_write_b32 v10, v16 offset:2048
    v_lshlrev_b32 v17, 16, v16
    v_and_b32 v18, 0xffff0000, v16
    v_readfirstlane_b32 s46, v17
    s_nop 1
    v_subrev_f32 v22, s46, v17
    v_subrev_f32 v24, s46, v18
    v_mul_f32 v23, v22, v22
    v_add_f32 v22, v22, v24
    v_fmac_f32 v23, v24, v24
    s_waitcnt lgkmcnt(0)
    ds_read_b128 v[24:27], v20 offset:2048
    ds_read_b128 v[28:31], v20 offset:2112
    v_add_f32_dpp v22, v22, v22 quad_perm:[1,0,3,2] row_mask:0xf bank_mask:0xf
    v_add_f32_dpp v23, v23, v23 quad_perm:[1,0,3,2] row_mask:0xf bank_mask:0xf
    s_nop 0
    v_add_f32_dpp v22, v22, v22 quad_perm:[2,3,0,1] row_mask:0xf bank_mask:0xf
    v_add_f32_dpp v23, v23, v23 quad_perm:[2,3,0,1] row_mask:0xf bank_mask:0xf
    s_nop 0
    v_add_f32_dpp v22, v22, v22 row_half_mirror row_mask:0xf bank_mask:0xf
    v_add_f32_dpp v23, v23, v23 row_half_mirror row_mask:0xf bank_mask:0xf
    s_nop 0
    v_add_f32_dpp v22, v22, v22 row_mirror row_mask:0xf bank_mask:0xf
    v_add_f32_dpp v23, v23, v23 row_mirror row_mask:0xf bank_mask:0xf
    v_mov_b32 v32, v22
    v_mov_b32 v33, v23
    s_waitcnt lgkmcnt(0)
    v_mfma_f32_16x16x32_bf16 v[104:107], v[24:27], v[48:51], v[104:107]
    v_permlane16_swap_b32 v22, v32
    v_mfma_f32_16x16x32_bf16 v[108:111], v[24:27], v[56:59], v[108:111]
    v_permlane16_swap_b32 v23, v33
    v_mfma_f32_16x16x32_bf16 v[112:115], v[24:27], v[64:67], v[112:115]
    v_mfma_f32_16x16x32_bf16 v[116:119], v[24:27], v[72:75], v[116:119]
    v_add_f32 v22, v22, v32
    v_add_f32 v23, v23, v33
    v_mfma_f32_16x16x32_bf16 v[104:107], v[28:31], v[52:55], v[104:107]
    v_mul_f32 v32, 0x3c800000, v22
    v_mfma_f32_16x16x32_bf16 v[108:111], v[28:31], v[60:63], v[108:111]
    v_fma_f32 v23, -v32, v22, v23
    v_add_f32 v22, s46, v32
    v_mfma_f32_16x16x32_bf16 v[112:115], v[28:31], v[68:71], v[112:115]
    v_mfma_f32_16x16x32_bf16 v[116:119], v[28:31], v[76:79], v[116:119]
    s_mov_b64 exec, 1
    ds_write_b64 v39, v[22:23] offset:128
    s_mov_b64 exec, 0xffff
    ds_write_b32 v21, v104 offset:7168
    ds_write_b32 v21, v108 offset:7232
    s_nop 1
    ds_write_b32 v21, v112 offset:7296
    ds_write_b32 v21, v116 offset:7360
    s_mov_b64 exec, -1
    s_cmp_gt_u32 s50, 15
    s_cbranch_scc1 L_noh
    s_lshr_b32 s44, s50, 1
    s_cmp_lg_u32 s44, s3
    s_cbranch_scc1 L_noh
    v_mov_b32_dpp v30, v16 quad_perm:[1,0,3,2] row_mask:0xf bank_mask:0xf
    v_mov_b32 v28, v16
    v_mov_b32 v29, s80
    v_mov_b32 v31, s80
    s_and_b32 s44, s50, 1
    s_lshl_b32 s44, s44, 4
    s_mov_b32 s47, 0
    s_mov_b32 s46, 0x5555
    s_lshl_b64 s[46:47], s[46:47], s44
    v_subrev_u32 v19, s44, v0
    v_lshlrev_b32 v19, 3, v19
    s_mov_b64 exec, s[46:47]
    buffer_store_dwordx4 v[28:31], v19, s[16:19], s38 offen offset:128 sc1
    s_mov_b64 exec, -1
L_noh:
    s_waitcnt lgkmcnt(0)
    s_barrier
    s_cmp_lg_u32 s3, 0
    s_cbranch_scc1 L_fin
    v_lshlrev_b32 v22, 2, v0
    ds_read_b64 v[24:25], v38 offset:128
    ds_read_b32 v88, v22 offset:7168
    ds_read_b32 v89, v22 offset:7424
    ds_read_b32 v90, v22 offset:7680
    ds_read_b32 v91, v22 offset:7936
    ds_read_b32 v92, v22 offset:8192
    ds_read_b32 v93, v22 offset:8448
    ds_read_b32 v94, v22 offset:8704
    ds_read_b32 v95, v22 offset:8960
    v_mov_b32 v13, s80
    v_mov_b32 v15, s80
    s_waitcnt lgkmcnt(8)
    v_add_f32_dpp v26, v24, v24 quad_perm:[1,0,3,2] row_mask:0xf bank_mask:0xf
    s_nop 1
    v_add_f32_dpp v26, v26, v26 quad_perm:[2,3,0,1] row_mask:0xf bank_mask:0xf
    s_nop 1
    v_add_f32_dpp v26, v26, v26 row_half_mirror row_mask:0xf bank_mask:0xf
    v_mul_f32 v26, 0x3e000000, v26
    v_sub_f32 v27, v24, v26
    v_mul_f32 v28, 0x42800000, v27
    v_fma_f32 v27, v28, v27, v25
    s_waitcnt lgkmcnt(0)
    s_nop 0
    v_add_f32_dpp v27, v27, v27 quad_perm:[1,0,3,2] row_mask:0xf bank_mask:0xf
    v_add_f32 v88, v88, v89
    v_add_f32 v90, v90, v91
    v_add_f32_dpp v27, v27, v27 quad_perm:[2,3,0,1] row_mask:0xf bank_mask:0xf
    v_add_f32 v92, v92, v93
    v_add_f32 v94, v94, v95
    v_add_f32_dpp v27, v27, v27 row_half_mirror row_mask:0xf bank_mask:0xf
    v_add_f32 v88, v88, v90
    v_add_f32 v92, v92, v94
    v_mul_f32 v27, 0x3b000000, v27
    v_add_f32 v88, v88, v92
    v_cvt_pk_bf16_f32 v31, v26, v26
    v_and_b32 v28, 0xffff0000, v31
    v_cvt_pk_bf16_f32 v31, v27, v27
    v_and_b32 v27, 0xffff0000, v31
    v_add_f32 v27, 0x3727c5ac, v27
    v_cvt_pk_bf16_f32 v31, v27, v27
    v_and_b32 v27, 0xffff0000, v31
    v_sqrt_f32 v29, v27
    s_nop 0
    v_cvt_pk_bf16_f32 v31, v29, v29
    v_and_b32 v29, 0xffff0000, v31
    v_rcp_f32 v30, v29
    v_fma_f32 v16, -v28, v40, v88
    v_mul_f32 v17, v16, v30
    v_fma_f32 v18, -v17, v29, v16
    v_fma_f32 v16, v18, v30, v17
    v_cvt_pk_bf16_f32 v17, v16, v16
    v_and_b32 v16, 0xffff0000, v17
    v_mov_b32 v17, v16
    s_nop 1
    v_permlane32_swap_b32 v16, v17
    v_mul_f32 v16, v16, v17
    s_nop 1
    v_mov_b32_dpp v17, v16 quad_perm:[1,0,3,2] row_mask:0xf bank_mask:0xf
    v_cvt_pk_bf16_f32 v12, v16, v17
    s_nop 1
    v_mov_b32_dpp v14, v12 quad_perm:[2,2,2,2] row_mask:0xf bank_mask:0xf
    s_mov_b32 exec_lo, 0x11111111
    s_mov_b32 exec_hi, 0
    buffer_store_dwordx4 v[12:15], v22, s[16:19], s38 offen sc1
    s_mov_b64 exec, -1
    s_branch L_fin
L_ffn2:
    v_lshrrev_b32 v106, 4, v0
    v_lshlrev_b32 v106, 9, v106
    v_bfe_u32 v47, v0, 2, 2
    v_lshlrev_b32 v47, 6, v47
    v_add_u32 v106, v106, v47
    v_and_b32 v47, 3, v0
    v_lshlrev_b32 v47, 3, v47
    v_add_u32 v106, v106, v47
    s_lshl_b32 s44, s3, 11
    s_add_u32 s44, s44, 25600
    v_add_u32 v106, s44, v106
    v_lshlrev_b32 v107, 2, v0
    s_lshl_b32 s44, s3, 8
    v_add_u32 v107, s44, v107
    v_lshrrev_b32 v108, 3, v0
    v_and_b32 v109, 7, v0
    v_lshlrev_b32 v110, 11, v108
    v_lshlrev_b32 v111, 4, v109
    v_add_u32 v110, v110, v111
    v_add_u32 v110, s44, v110
    s_lshl_b32 s45, s50, 8
    s_add_u32 s45, s45, 128
    v_add_u32 v111, s45, v111
    v_cmp_eq_u32 vcc, 6, v108
    s_nop 1
    v_cndmask_b32 v110, v110, v111, vcc
    s_lshl_b32 s45, s3, 9
    v_lshlrev_b32 v108, 6, v108
    v_lshlrev_b32 v109, 3, v109
    v_add_u32 v108, v108, v109
    v_add_u32 v108, s45, v108
    v_lshrrev_b32 v109, 4, v0
    v_lshlrev_b32 v109, 4, v109
    v_add_u32 v109, s45, v109
    s_cmp_lt_u32 s3, 3
    s_cselect_b32 s45, 48, 40
    s_cmp_eq_u32 s3, 0
    s_cselect_b32 s45, 56, s45
    s_mov_b64 s[46:47], 1
    s_lshl_b64 s[46:47], s[46:47], s45
    s_sub_u32 s46, s46, 1
    s_subb_u32 s47, s47, 0
    s_mov_b32 s48, 0x110000
    s_waitcnt vmcnt(0)
    ds_read_b64_tr_b16 v[8:9], v106 offset:0
    ds_read_b64_tr_b16 v[10:11], v106 offset:256
    ds_read_b64_tr_b16 v[12:13], v106 offset:32
    ds_read_b64_tr_b16 v[14:15], v106 offset:288
    ds_read_b64_tr_b16 v[16:17], v106 offset:16384
    ds_read_b64_tr_b16 v[18:19], v106 offset:16640
    ds_read_b64_tr_b16 v[20:21], v106 offset:16416
    ds_read_b64_tr_b16 v[22:23], v106 offset:16672
    ds_read_b64_tr_b16 v[24:25], v106 offset:32768
    ds_read_b64_tr_b16 v[26:27], v106 offset:33024
    ds_read_b64_tr_b16 v[28:29], v106 offset:32800
    ds_read_b64_tr_b16 v[30:31], v106 offset:33056
    ds_read_b64_tr_b16 v[32:33], v106 offset:49152
    ds_read_b64_tr_b16 v[34:35], v106 offset:49408
    ds_read_b64_tr_b16 v[36:37], v106 offset:49184
    ds_read_b64_tr_b16 v[38:39], v106 offset:49440
    v_add_u32 v105, 65536, v106
    ds_read_b64_tr_b16 v[40:41], v105 offset:0
    ds_read_b64_tr_b16 v[42:43], v105 offset:256
    ds_read_b64_tr_b16 v[44:45], v105 offset:32
    ds_read_b64_tr_b16 v[46:47], v105 offset:288
    s_cmp_gt_u32 s3, 2
    s_cbranch_scc1 L_d5
    v_add_u32 v105, 81920, v106
    ds_read_b64_tr_b16 v[48:49], v105 offset:0
    ds_read_b64_tr_b16 v[50:51], v105 offset:256
    ds_read_b64_tr_b16 v[52:53], v105 offset:32
    ds_read_b64_tr_b16 v[54:55], v105 offset:288
L_d5:
    v_mov_b32 v112, 0
    v_mov_b32 v113, 0
    v_mov_b32 v114, 0
    v_mov_b32 v115, 0
    v_mov_b32 v116, 0
    v_mov_b32 v117, 0
    v_mov_b32 v118, 0
    v_mov_b32 v119, 0
    s_mov_b64 exec, s[46:47]
    s_mov_b32 s40, 0
L_pollD_26:
    buffer_load_dwordx4 v[80:83], v110, s[16:19], s48 offen offset:0 sc1
    s_waitcnt vmcnt(0)
    v_xor_b32 v140, s80, v81
    v_xor_b32 v141, s80, v83
    v_or_b32 v140, v140, v141
    v_cmp_eq_u32 s[42:43], 0, v140
    s_nop 0
    s_cmp_eq_u64 s[42:43], exec
    s_cbranch_scc1 L_okD_27
    s_add_u32 s40, s40, 1
    s_cmp_lt_u32 s40, 200000
    s_cbranch_scc1 L_pollD_26
L_okD_27:
    v_mov_b32 v81, v82
    ds_write_b64 v108, v[80:81] offset:3072
    s_mov_b64 exec, -1
    s_waitcnt lgkmcnt(0)
    ds_read_b128 v[56:59], v109 offset:3072
    ds_read_b128 v[60:63], v109 offset:3136
    ds_read_b128 v[64:67], v109 offset:3200
    ds_read_b128 v[68:71], v109 offset:3264
    ds_read_b128 v[72:75], v109 offset:3328
    ds_read_b128 v[76:79], v109 offset:3392
    s_waitcnt lgkmcnt(0)
    v_mfma_f32_16x16x32_bf16 v[112:115], v[56:59], v[8:11], v[112:115]
    v_mfma_f32_16x16x32_bf16 v[116:119], v[56:59], v[12:15], v[116:119]
    v_mfma_f32_16x16x32_bf16 v[112:115], v[60:63], v[16:19], v[112:115]
    v_mfma_f32_16x16x32_bf16 v[116:119], v[60:63], v[20:23], v[116:119]
    v_mfma_f32_16x16x32_bf16 v[112:115], v[64:67], v[24:27], v[112:115]
    v_mfma_f32_16x16x32_bf16 v[116:119], v[64:67], v[28:31], v[116:119]
    v_mfma_f32_16x16x32_bf16 v[112:115], v[68:71], v[32:35], v[112:115]
    v_mfma_f32_16x16x32_bf16 v[116:119], v[68:71], v[36:39], v[116:119]
    v_mfma_f32_16x16x32_bf16 v[112:115], v[72:75], v[40:43], v[112:115]
    v_mfma_f32_16x16x32_bf16 v[116:119], v[72:75], v[44:47], v[116:119]
    s_cmp_gt_u32 s3, 2
    s_cbranch_scc1 L_dacc
    v_mfma_f32_16x16x32_bf16 v[112:115], v[76:79], v[48:51], v[112:115]
    v_mfma_f32_16x16x32_bf16 v[116:119], v[76:79], v[52:55], v[116:119]
L_dacc:
    s_mov_b64 exec, 0xffff
    s_nop 5
    ds_write_b32 v107, v112 offset:7168
    ds_write_b32 v107, v116 offset:7232
    s_mov_b64 exec, -1
    s_waitcnt lgkmcnt(0)
    s_barrier
    s_cmp_lg_u32 s3, 0
    s_cbranch_scc1 L_fin
    v_lshlrev_b32 v22, 2, v0
    v_lshlrev_b32 v20, 1, v0
    s_mov_b32 exec_hi, 0
    ds_read_b32 v8, v22 offset:7168
    ds_read_b32 v9, v22 offset:7424
    ds_read_b32 v10, v22 offset:7680
    ds_read_b32 v11, v22 offset:7936
    ds_read_b32 v12, v22 offset:8192
    ds_read_b32 v13, v22 offset:8448
    ds_read_b32 v14, v22 offset:8704
    ds_read_b32 v15, v22 offset:8960
    ds_read_u16 v17, v20 offset:3456
    s_lshl_b32 s44, s50, 6
    s_mov_b32 s8, s74
    s_mov_b32 s9, s75
    s_mov_b32 s10, 0x400
    s_mov_b32 s11, 0x20000
    s_waitcnt lgkmcnt(0)
    v_add_f32 v8, v8, v9
    v_add_f32 v10, v10, v11
    v_add_f32 v12, v12, v13
    v_add_f32 v14, v14, v15
    v_lshlrev_b32 v17, 16, v17
    v_add_f32 v8, v8, v10
    v_add_f32 v12, v12, v14
    v_add_f32 v8, v8, v12
    v_cvt_pk_bf16_f32 v9, v8, v8
    v_and_b32 v8, 0xffff0000, v9
    v_add_f32 v8, v8, v17
    v_cvt_pk_bf16_f32 v8, v8, v8
    buffer_store_short v8, v20, s[8:11], s44 offen
    s_mov_b64 exec, -1
    s_cmp_lg_u32 s50, 0
    s_cbranch_scc1 L_fin
    v_mov_b32 v5, s80
    s_mov_b64 exec, 1
    buffer_store_dword v5, off, s[16:19], 0 offset:0
    s_mov_b64 exec, -1
L_fin:
    s_endpgm
L_helper:
    s_setprio 3
    s_waitcnt lgkmcnt(0)
    s_load_dword s80, s[78:79], 0
    s_mov_b32 s8, s56
    s_mov_b32 s9, s57
    s_mov_b32 s10, 0x400
    s_mov_b32 s11, 0x20000
    v_lshlrev_b32 v1, 4, v0
    buffer_load_dwordx4 v[8:11], v1, s[8:11], 0 offen
    s_lshr_b32 s44, s5, 3
    s_lshl_b32 s44, s44, 3
    s_add_u32 s44, s44, s4
    s_and_b32 s45, s5, 7
    s_mov_b32 s12, s62
    s_mov_b32 s13, s63
    s_mov_b32 s14, 0x400000
    s_mov_b32 s15, 0x20000
    v_lshrrev_b32 v4, 1, v0
    v_and_b32 v5, 1, v0
    v_lshlrev_b32 v5, 4, v5
    v_lshlrev_b32 v6, 13, v4
    v_add_u32 v6, v6, v5
    s_lshl_b32 s46, s44, 8
    s_lshl_b32 s48, s45, 5
    s_add_u32 s46, s46, s48
    s_mov_b32 m0, 9216
    s_add_u32 s48, s46, 0
    buffer_load_dwordx4 v6, s[12:15], s48 offen nt lds
    s_mov_b32 m0, 10240
    s_add_u32 s48, s46, 262144
    buffer_load_dwordx4 v6, s[12:15], s48 offen nt lds
    s_mov_b32 m0, 11264
    s_add_u32 s48, s46, 524288
    buffer_load_dwordx4 v6, s[12:15], s48 offen nt lds
    s_mov_b32 m0, 12288
    s_add_u32 s48, s46, 786432
    buffer_load_dwordx4 v6, s[12:15], s48 offen nt lds
    s_mov_b32 m0, 13312
    s_add_u32 s48, s46, 1048576
    buffer_load_dwordx4 v6, s[12:15], s48 offen nt lds
    s_mov_b32 m0, 14336
    s_add_u32 s48, s46, 1310720
    buffer_load_dwordx4 v6, s[12:15], s48 offen nt lds
    s_mov_b32 m0, 15360
    s_add_u32 s48, s46, 1572864
    buffer_load_dwordx4 v6, s[12:15], s48 offen nt lds
    s_mov_b32 m0, 16384
    s_add_u32 s48, s46, 1835008
    buffer_load_dwordx4 v6, s[12:15], s48 offen nt lds
    s_mov_b32 m0, 17408
    s_add_u32 s48, s46, 2097152
    buffer_load_dwordx4 v6, s[12:15], s48 offen nt lds
    s_mov_b32 m0, 18432
    s_add_u32 s48, s46, 2359296
    buffer_load_dwordx4 v6, s[12:15], s48 offen nt lds
    s_mov_b32 m0, 19456
    s_add_u32 s48, s46, 2621440
    buffer_load_dwordx4 v6, s[12:15], s48 offen nt lds
    s_mov_b32 m0, 20480
    s_add_u32 s48, s46, 2883584
    buffer_load_dwordx4 v6, s[12:15], s48 offen nt lds
    s_mov_b32 m0, 21504
    s_add_u32 s48, s46, 3145728
    buffer_load_dwordx4 v6, s[12:15], s48 offen nt lds
    s_mov_b32 m0, 22528
    s_add_u32 s48, s46, 3407872
    buffer_load_dwordx4 v6, s[12:15], s48 offen nt lds
    s_mov_b32 m0, 23552
    s_add_u32 s48, s46, 3670016
    buffer_load_dwordx4 v6, s[12:15], s48 offen nt lds
    s_mov_b32 m0, 24576
    s_add_u32 s48, s46, 3932160
    buffer_load_dwordx4 v6, s[12:15], s48 offen nt lds
    s_mov_b32 s16, s78
    s_mov_b32 s17, s79
    s_mov_b32 s18, 0x40000000
    s_mov_b32 s19, 0x20000
    s_cmp_lg_u32 s45, 0
    s_cbranch_scc1 L_noinit
    s_mul_i32 s46, s44, 4352
    s_add_u32 s46, s46, 0x1000
    s_mov_b64 exec, 1
    buffer_store_dword v42, off, s[16:19], s46 sc1
    s_mov_b64 exec, -1
L_noinit:
    v_mov_b32 v14, 24
    ds_write_b32 v42, v14 offset:0
    ds_write_b32 v42, v42 offset:4
    ds_write_b32 v42, v42 offset:8
    v_lshlrev_b32 v12, 2, v0
    v_mov_b32 v13, -1
    ds_write_b32 v12, v13 offset:512
    ds_write_b32 v12, v13 offset:768
    ds_write_b32 v12, v13 offset:1024
    ds_write_b32 v12, v13 offset:1280
    ds_write_b32 v12, v13 offset:1536
    ds_write_b32 v12, v13 offset:1792
    s_waitcnt vmcnt(17)
    s_cmp_lg_u32 s45, 0
    s_cbranch_scc0 L_xw
    s_waitcnt vmcnt(16)
L_xw:
    v_lshlrev_b32 v12, 16, v8
    v_and_b32 v13, 0xffff0000, v8
    v_lshlrev_b32 v14, 16, v9
    v_and_b32 v15, 0xffff0000, v9
    v_lshlrev_b32 v16, 16, v10
    v_and_b32 v17, 0xffff0000, v10
    v_lshlrev_b32 v18, 16, v11
    v_and_b32 v19, 0xffff0000, v11
    v_add_f32 v20, v12, v13
    v_add_f32 v21, v14, v15
    v_add_f32 v22, v16, v17
    v_add_f32 v23, v18, v19
    v_add_f32 v20, v20, v21
    v_add_f32 v22, v22, v23
    v_add_f32 v20, v20, v22
    s_nop 1
    v_add_f32_dpp v20, v20, v20 quad_perm:[1,0,3,2] row_mask:0xf bank_mask:0xf
    s_nop 1
    v_add_f32_dpp v20, v20, v20 quad_perm:[2,3,0,1] row_mask:0xf bank_mask:0xf
    s_nop 1
    v_add_f32_dpp v20, v20, v20 row_half_mirror row_mask:0xf bank_mask:0xf
    s_nop 1
    v_add_f32_dpp v20, v20, v20 row_mirror row_mask:0xf bank_mask:0xf
    s_nop 0
    v_readlane_b32 s32, v20, 0
    v_readlane_b32 s33, v20, 16
    v_readlane_b32 s34, v20, 32
    v_readlane_b32 s35, v20, 48
    s_nop 1
    v_mov_b32 v20, s32
    v_add_f32 v20, s33, v20
    v_add_f32 v20, s34, v20
    v_add_f32 v20, s35, v20
    v_mul_f32 v20, 0x3b000000, v20
    v_sub_f32 v22, v12, v20
    v_mul_f32 v21, v22, v22
    v_sub_f32 v22, v13, v20
    v_fmac_f32 v21, v22, v22
    v_sub_f32 v22, v14, v20
    v_fmac_f32 v21, v22, v22
    v_sub_f32 v22, v15, v20
    v_fmac_f32 v21, v22, v22
    v_sub_f32 v22, v16, v20
    v_fmac_f32 v21, v22, v22
    v_sub_f32 v22, v17, v20
    v_fmac_f32 v21, v22, v22
    v_sub_f32 v22, v18, v20
    v_fmac_f32 v21, v22, v22
    v_sub_f32 v22, v19, v20
    v_fmac_f32 v21, v22, v22
    s_nop 1
    v_add_f32_dpp v21, v21, v21 quad_perm:[1,0,3,2] row_mask:0xf bank_mask:0xf
    s_nop 1
    v_add_f32_dpp v21, v21, v21 quad_perm:[2,3,0,1] row_mask:0xf bank_mask:0xf
    s_nop 1
    v_add_f32_dpp v21, v21, v21 row_half_mirror row_mask:0xf bank_mask:0xf
    s_nop 1
    v_add_f32_dpp v21, v21, v21 row_mirror row_mask:0xf bank_mask:0xf
    s_nop 0
    v_readlane_b32 s32, v21, 0
    v_readlane_b32 s33, v21, 16
    v_readlane_b32 s34, v21, 32
    v_readlane_b32 s35, v21, 48
    s_nop 1
    v_mov_b32 v21, s32
    v_add_f32 v21, s33, v21
    v_add_f32 v21, s34, v21
    v_add_f32 v21, s35, v21
    v_mul_f32 v21, 0x3b000000, v21
    v_cvt_pk_bf16_f32 v25, v20, v20
    v_and_b32 v22, 0xffff0000, v25
    v_cvt_pk_bf16_f32 v25, v21, v21
    v_and_b32 v21, 0xffff0000, v25
    v_add_f32 v21, 0x3727c5ac, v21
    v_cvt_pk_bf16_f32 v25, v21, v21
    v_and_b32 v21, 0xffff0000, v25
    v_sqrt_f32 v23, v21
    s_nop 0
    v_cvt_pk_bf16_f32 v25, v23, v23
    v_and_b32 v23, 0xffff0000, v25
    v_rcp_f32 v24, v23
    v_sub_f32 v12, v12, v22
    v_cvt_pk_bf16_f32 v25, v12, v12
    v_and_b32 v12, 0xffff0000, v25
    v_mul_f32 v25, v12, v24
    v_fma_f32 v26, -v25, v23, v12
    v_fma_f32 v12, v26, v24, v25
    v_sub_f32 v13, v13, v22
    v_cvt_pk_bf16_f32 v27, v13, v13
    v_and_b32 v13, 0xffff0000, v27
    v_mul_f32 v27, v13, v24
    v_fma_f32 v28, -v27, v23, v13
    v_fma_f32 v13, v28, v24, v27
    v_sub_f32 v14, v14, v22
    v_cvt_pk_bf16_f32 v25, v14, v14
    v_and_b32 v14, 0xffff0000, v25
    v_mul_f32 v25, v14, v24
    v_fma_f32 v26, -v25, v23, v14
    v_fma_f32 v14, v26, v24, v25
    v_sub_f32 v15, v15, v22
    v_cvt_pk_bf16_f32 v27, v15, v15
    v_and_b32 v15, 0xffff0000, v27
    v_mul_f32 v27, v15, v24
    v_fma_f32 v28, -v27, v23, v15
    v_fma_f32 v15, v28, v24, v27
    v_sub_f32 v16, v16, v22
    v_cvt_pk_bf16_f32 v25, v16, v16
    v_and_b32 v16, 0xffff0000, v25
    v_mul_f32 v25, v16, v24
    v_fma_f32 v26, -v25, v23, v16
    v_fma_f32 v16, v26, v24, v25
    v_sub_f32 v17, v17, v22
    v_cvt_pk_bf16_f32 v27, v17, v17
    v_and_b32 v17, 0xffff0000, v27
    v_mul_f32 v27, v17, v24
    v_fma_f32 v28, -v27, v23, v17
    v_fma_f32 v17, v28, v24, v27
    v_sub_f32 v18, v18, v22
    v_cvt_pk_bf16_f32 v25, v18, v18
    v_and_b32 v18, 0xffff0000, v25
    v_mul_f32 v25, v18, v24
    v_fma_f32 v26, -v25, v23, v18
    v_fma_f32 v18, v26, v24, v25
    v_sub_f32 v19, v19, v22
    v_cvt_pk_bf16_f32 v27, v19, v19
    v_and_b32 v19, 0xffff0000, v27
    v_mul_f32 v27, v19, v24
    v_fma_f32 v28, -v27, v23, v19
    v_fma_f32 v19, v28, v24, v27
    v_cvt_pk_bf16_f32 v8, v12, v13
    v_cvt_pk_bf16_f32 v9, v14, v15
    v_cvt_pk_bf16_f32 v10, v16, v17
    v_cvt_pk_bf16_f32 v11, v18, v19
    ds_write_b128 v1, v[8:11] offset:2048
    v_lshrrev_b32 v4, 4, v0
    v_lshlrev_b32 v7, 4, v4
    v_lshlrev_b32 v4, 8, v4
    v_bfe_u32 v5, v0, 2, 2
    v_lshlrev_b32 v5, 5, v5
    v_add_u32 v4, v4, v5
    v_and_b32 v5, 3, v0
    v_lshlrev_b32 v5, 3, v5
    v_add_u32 v4, v4, v5
    s_waitcnt vmcnt(0) lgkmcnt(0)
    ds_read_b128 v[8:11], v7 offset:2048
    ds_read_b64_tr_b16 v[72:73], v4 offset:9216
    ds_read_b64_tr_b16 v[74:75], v4 offset:9344
    ds_read_b128 v[12:15], v7 offset:2112
    ds_read_b64_tr_b16 v[76:77], v4 offset:10240
    ds_read_b64_tr_b16 v[78:79], v4 offset:10368
    ds_read_b128 v[16:19], v7 offset:2176
    ds_read_b64_tr_b16 v[80:81], v4 offset:11264
    ds_read_b64_tr_b16 v[82:83], v4 offset:11392
    ds_read_b128 v[20:23], v7 offset:2240
    ds_read_b64_tr_b16 v[84:85], v4 offset:12288
    ds_read_b64_tr_b16 v[86:87], v4 offset:12416
    ds_read_b128 v[24:27], v7 offset:2304
    ds_read_b64_tr_b16 v[88:89], v4 offset:13312
    ds_read_b64_tr_b16 v[90:91], v4 offset:13440
    ds_read_b128 v[28:31], v7 offset:2368
    ds_read_b64_tr_b16 v[92:93], v4 offset:14336
    ds_read_b64_tr_b16 v[94:95], v4 offset:14464
    ds_read_b128 v[32:35], v7 offset:2432
    ds_read_b64_tr_b16 v[96:97], v4 offset:15360
    ds_read_b64_tr_b16 v[98:99], v4 offset:15488
    ds_read_b128 v[36:39], v7 offset:2496
    ds_read_b64_tr_b16 v[100:101], v4 offset:16384
    ds_read_b64_tr_b16 v[102:103], v4 offset:16512
    ds_read_b128 v[40:43], v7 offset:2560
    ds_read_b64_tr_b16 v[104:105], v4 offset:17408
    ds_read_b64_tr_b16 v[106:107], v4 offset:17536
    ds_read_b128 v[44:47], v7 offset:2624
    ds_read_b64_tr_b16 v[108:109], v4 offset:18432
    ds_read_b64_tr_b16 v[110:111], v4 offset:18560
    ds_read_b128 v[48:51], v7 offset:2688
    ds_read_b64_tr_b16 v[112:113], v4 offset:19456
    ds_read_b64_tr_b16 v[114:115], v4 offset:19584
    ds_read_b128 v[52:55], v7 offset:2752
    ds_read_b64_tr_b16 v[116:117], v4 offset:20480
    ds_read_b64_tr_b16 v[118:119], v4 offset:20608
    ds_read_b128 v[56:59], v7 offset:2816
    ds_read_b64_tr_b16 v[120:121], v4 offset:21504
    ds_read_b64_tr_b16 v[122:123], v4 offset:21632
    ds_read_b128 v[60:63], v7 offset:2880
    ds_read_b64_tr_b16 v[124:125], v4 offset:22528
    ds_read_b64_tr_b16 v[126:127], v4 offset:22656
    ds_read_b128 v[64:67], v7 offset:2944
    ds_read_b64_tr_b16 v[128:129], v4 offset:23552
    ds_read_b64_tr_b16 v[130:131], v4 offset:23680
    ds_read_b128 v[68:71], v7 offset:3008
    ds_read_b64_tr_b16 v[132:133], v4 offset:24576
    ds_read_b64_tr_b16 v[134:135], v4 offset:24704
    v_mov_b32 v136, 0
    v_mov_b32 v137, 0
    v_mov_b32 v138, 0
    v_mov_b32 v139, 0
    s_add_u32 s80, s80, 0x9e3779b9
    s_lshl_b32 s46, s44, 9
    s_lshl_b32 s48, s45, 6
    s_add_u32 s46, s46, s48
    s_add_u32 s46, s46, 0x40000
    s_waitcnt lgkmcnt(0)
    v_mfma_f32_16x16x32_bf16 v[136:139], v[8:11], v[72:75], v[136:139]
    v_mfma_f32_16x16x32_bf16 v[136:139], v[12:15], v[76:79], v[136:139]
    v_mfma_f32_16x16x32_bf16 v[136:139], v[16:19], v[80:83], v[136:139]
    v_mfma_f32_16x16x32_bf16 v[136:139], v[20:23], v[84:87], v[136:139]
    v_mfma_f32_16x16x32_bf16 v[136:139], v[24:27], v[88:91], v[136:139]
    v_mfma_f32_16x16x32_bf16 v[136:139], v[28:31], v[92:95], v[136:139]
    v_mfma_f32_16x16x32_bf16 v[136:139], v[32:35], v[96:99], v[136:139]
    v_mfma_f32_16x16x32_bf16 v[136:139], v[36:39], v[100:103], v[136:139]
    v_mfma_f32_16x16x32_bf16 v[136:139], v[40:43], v[104:107], v[136:139]
    v_mfma_f32_16x16x32_bf16 v[136:139], v[44:47], v[108:111], v[136:139]
    v_mfma_f32_16x16x32_bf16 v[136:139], v[48:51], v[112:115], v[136:139]
    v_mfma_f32_16x16x32_bf16 v[136:139], v[52:55], v[116:119], v[136:139]
    v_mfma_f32_16x16x32_bf16 v[136:139], v[56:59], v[120:123], v[136:139]
    v_mfma_f32_16x16x32_bf16 v[136:139], v[60:63], v[124:127], v[136:139]
    v_mfma_f32_16x16x32_bf16 v[136:139], v[64:67], v[128:131], v[136:139]
    v_mfma_f32_16x16x32_bf16 v[136:139], v[68:71], v[132:135], v[136:139]
    v_mov_b32 v11, s80
    v_lshlrev_b32 v12, 2, v0
    s_nop 5
    v_mov_b32_dpp v9, v136 quad_perm:[1,0,3,2] row_mask:0xf bank_mask:0xf
    v_cvt_pk_bf16_f32 v8, v136, v9
    s_nop 1
    v_mov_b32_dpp v10, v8 quad_perm:[2,2,2,2] row_mask:0xf bank_mask:0xf
    v_mov_b32 v9, s80
    s_mov_b64 exec, 0x1111
    buffer_store_dwordx4 v[8:11], v12, s[16:19], s46 offen sc1
    s_mov_b64 exec, -1
    s_lshl_b32 s46, s5, 9
    s_add_u32 s46, s46, 0x40000
    s_add_u32 s6, s78, s46
    s_addc_u32 s7, s79, 0
    s_mov_b32 s8, s80
    s_mov_b32 s9, 0
L_sq_28:
    s_load_dwordx16 s[32:47], s[6:7], 0 glc
    s_load_dwordx16 s[48:63], s[6:7], 64 glc
    s_load_dwordx16 s[64:79], s[6:7], 128 glc
    s_load_dwordx16 s[80:95], s[6:7], 192 glc
    s_waitcnt lgkmcnt(0)
    s_xor_b32 s10, s33, s8
    s_xor_b32 s11, s35, s8
    s_or_b32 s10, s10, s11
    s_xor_b32 s11, s37, s8
    s_or_b32 s10, s10, s11
    s_xor_b32 s11, s39, s8
    s_or_b32 s10, s10, s11
    s_xor_b32 s11, s41, s8
    s_or_b32 s10, s10, s11
    s_xor_b32 s11, s43, s8
    s_or_b32 s10, s10, s11
    s_xor_b32 s11, s45, s8
    s_or_b32 s10, s10, s11
    s_xor_b32 s11, s47, s8
    s_or_b32 s10, s10, s11
    s_xor_b32 s11, s49, s8
    s_or_b32 s10, s10, s11
    s_xor_b32 s11, s51, s8
    s_or_b32 s10, s10, s11
    s_xor_b32 s11, s53, s8
    s_or_b32 s10, s10, s11
    s_xor_b32 s11, s55, s8
    s_or_b32 s10, s10, s11
    s_xor_b32 s11, s57, s8
    s_or_b32 s10, s10, s11
    s_xor_b32 s11, s59, s8
    s_or_b32 s10, s10, s11
    s_xor_b32 s11, s61, s8
    s_or_b32 s10, s10, s11
    s_xor_b32 s11, s63, s8
    s_or_b32 s10, s10, s11
    s_xor_b32 s11, s65, s8
    s_or_b32 s10, s10, s11
    s_xor_b32 s11, s67, s8
    s_or_b32 s10, s10, s11
    s_xor_b32 s11, s69, s8
    s_or_b32 s10, s10, s11
    s_xor_b32 s11, s71, s8
    s_or_b32 s10, s10, s11
    s_xor_b32 s11, s73, s8
    s_or_b32 s10, s10, s11
    s_xor_b32 s11, s75, s8
    s_or_b32 s10, s10, s11
    s_xor_b32 s11, s77, s8
    s_or_b32 s10, s10, s11
    s_xor_b32 s11, s79, s8
    s_or_b32 s10, s10, s11
    s_xor_b32 s11, s81, s8
    s_or_b32 s10, s10, s11
    s_xor_b32 s11, s83, s8
    s_or_b32 s10, s10, s11
    s_xor_b32 s11, s85, s8
    s_or_b32 s10, s10, s11
    s_xor_b32 s11, s87, s8
    s_or_b32 s10, s10, s11
    s_xor_b32 s11, s89, s8
    s_or_b32 s10, s10, s11
    s_xor_b32 s11, s91, s8
    s_or_b32 s10, s10, s11
    s_xor_b32 s11, s93, s8
    s_or_b32 s10, s10, s11
    s_xor_b32 s11, s95, s8
    s_or_b32 s10, s10, s11
    s_cmp_eq_u32 s10, 0
    s_cbranch_scc1 L_sqok_29
    s_add_u32 s9, s9, 1
    s_cmp_lt_u32 s9, 200000
    s_cbranch_scc1 L_sq_28
L_sqok_29:
    v_writelane_b32 v16, s32, 0
    v_writelane_b32 v16, s34, 1
    v_writelane_b32 v16, s36, 2
    v_writelane_b32 v16, s38, 3
    v_writelane_b32 v16, s40, 4
    v_writelane_b32 v16, s42, 5
    v_writelane_b32 v16, s44, 6
    v_writelane_b32 v16, s46, 7
    v_writelane_b32 v16, s48, 8
    v_writelane_b32 v16, s50, 9
    v_writelane_b32 v16, s52, 10
    v_writelane_b32 v16, s54, 11
    v_writelane_b32 v16, s56, 12
    v_writelane_b32 v16, s58, 13
    v_writelane_b32 v16, s60, 14
    v_writelane_b32 v16, s62, 15
    v_writelane_b32 v16, s64, 16
    v_writelane_b32 v16, s66, 17
    v_writelane_b32 v16, s68, 18
    v_writelane_b32 v16, s70, 19
    v_writelane_b32 v16, s72, 20
    v_writelane_b32 v16, s74, 21
    v_writelane_b32 v16, s76, 22
    v_writelane_b32 v16, s78, 23
    v_writelane_b32 v16, s80, 24
    v_writelane_b32 v16, s82, 25
    v_writelane_b32 v16, s84, 26
    v_writelane_b32 v16, s86, 27
    v_writelane_b32 v16, s88, 28
    v_writelane_b32 v16, s90, 29
    v_writelane_b32 v16, s92, 30
    v_writelane_b32 v16, s94, 31
    s_mov_b32 s9, 0
L_sq_30:
    s_load_dwordx16 s[32:47], s[6:7], 256 glc
    s_load_dwordx16 s[48:63], s[6:7], 320 glc
    s_load_dwordx16 s[64:79], s[6:7], 384 glc
    s_load_dwordx16 s[80:95], s[6:7], 448 glc
    s_waitcnt lgkmcnt(0)
    s_xor_b32 s10, s33, s8
    s_xor_b32 s11, s35, s8
    s_or_b32 s10, s10, s11
    s_xor_b32 s11, s37, s8
    s_or_b32 s10, s10, s11
    s_xor_b32 s11, s39, s8
    s_or_b32 s10, s10, s11
    s_xor_b32 s11, s41, s8
    s_or_b32 s10, s10, s11
    s_xor_b32 s11, s43, s8
    s_or_b32 s10, s10, s11
    s_xor_b32 s11, s45, s8
    s_or_b32 s10, s10, s11
    s_xor_b32 s11, s47, s8
    s_or_b32 s10, s10, s11
    s_xor_b32 s11, s49, s8
    s_or_b32 s10, s10, s11
    s_xor_b32 s11, s51, s8
    s_or_b32 s10, s10, s11
    s_xor_b32 s11, s53, s8
    s_or_b32 s10, s10, s11
    s_xor_b32 s11, s55, s8
    s_or_b32 s10, s10, s11
    s_xor_b32 s11, s57, s8
    s_or_b32 s10, s10, s11
    s_xor_b32 s11, s59, s8
    s_or_b32 s10, s10, s11
    s_xor_b32 s11, s61, s8
    s_or_b32 s10, s10, s11
    s_xor_b32 s11, s63, s8
    s_or_b32 s10, s10, s11
    s_xor_b32 s11, s65, s8
    s_or_b32 s10, s10, s11
    s_xor_b32 s11, s67, s8
    s_or_b32 s10, s10, s11
    s_xor_b32 s11, s69, s8
    s_or_b32 s10, s10, s11
    s_xor_b32 s11, s71, s8
    s_or_b32 s10, s10, s11
    s_xor_b32 s11, s73, s8
    s_or_b32 s10, s10, s11
    s_xor_b32 s11, s75, s8
    s_or_b32 s10, s10, s11
    s_xor_b32 s11, s77, s8
    s_or_b32 s10, s10, s11
    s_xor_b32 s11, s79, s8
    s_or_b32 s10, s10, s11
    s_xor_b32 s11, s81, s8
    s_or_b32 s10, s10, s11
    s_xor_b32 s11, s83, s8
    s_or_b32 s10, s10, s11
    s_xor_b32 s11, s85, s8
    s_or_b32 s10, s10, s11
    s_xor_b32 s11, s87, s8
    s_or_b32 s10, s10, s11
    s_xor_b32 s11, s89, s8
    s_or_b32 s10, s10, s11
    s_xor_b32 s11, s91, s8
    s_or_b32 s10, s10, s11
    s_xor_b32 s11, s93, s8
    s_or_b32 s10, s10, s11
    s_xor_b32 s11, s95, s8
    s_or_b32 s10, s10, s11
    s_cmp_eq_u32 s10, 0
    s_cbranch_scc1 L_sqok_31
    s_add_u32 s9, s9, 1
    s_cmp_lt_u32 s9, 200000
    s_cbranch_scc1 L_sq_30
L_sqok_31:
    v_writelane_b32 v16, s32, 32
    v_writelane_b32 v16, s34, 33
    v_writelane_b32 v16, s36, 34
    v_writelane_b32 v16, s38, 35
    v_writelane_b32 v16, s40, 36
    v_writelane_b32 v16, s42, 37
    v_writelane_b32 v16, s44, 38
    v_writelane_b32 v16, s46, 39
    v_writelane_b32 v16, s48, 40
    v_writelane_b32 v16, s50, 41
    v_writelane_b32 v16, s52, 42
    v_writelane_b32 v16, s54, 43
    v_writelane_b32 v16, s56, 44
    v_writelane_b32 v16, s58, 45
    v_writelane_b32 v16, s60, 46
    v_writelane_b32 v16, s62, 47
    v_writelane_b32 v16, s64, 48
    v_writelane_b32 v16, s66, 49
    v_writelane_b32 v16, s68, 50
    v_writelane_b32 v16, s70, 51
    v_writelane_b32 v16, s72, 52
    v_writelane_b32 v16, s74, 53
    v_writelane_b32 v16, s76, 54
    v_writelane_b32 v16, s78, 55
    v_writelane_b32 v16, s80, 56
    v_writelane_b32 v16, s82, 57
    v_writelane_b32 v16, s84, 58
    v_writelane_b32 v16, s86, 59
    v_writelane_b32 v16, s88, 60
    v_writelane_b32 v16, s90, 61
    v_writelane_b32 v16, s92, 62
    v_writelane_b32 v16, s94, 63
    v_lshlrev_b32 v12, 2, v0
    ds_write_b32 v12, v16 offset:256
    s_load_dwordx8 s[72:79], s[0:1], 64
    s_mov_b32 s80, s8
    s_waitcnt lgkmcnt(0)
    s_barrier
    s_mul_i32 s46, s5, 4352
    s_add_u32 s46, s46, 0x1000
    s_add_u32 s24, s78, s46
    s_addc_u32 s25, s79, 0
    s_mov_b32 s26, 0x4
    s_mov_b32 s27, 0x20000
    s_mov_b32 s44, 0
    s_mov_b32 s45, 93
    s_mov_b32 s47, 0
    v_mov_b32 v42, 0
L_disp:
    ds_read_b32 v36, v42 offset:0
    s_waitcnt lgkmcnt(0)
    v_readfirstlane_b32 s46, v36
    s_nop 0
    s_cmp_ge_u32 s46, s45
    s_cbranch_scc1 L_fetch
    s_add_u32 s47, s47, 1
    s_cmp_lt_u32 s47, 0x400000
    s_cbranch_scc1 L_disp
    s_branch L_exh
L_fetch:
    v_mov_b32 v34, 1
    s_mov_b64 exec, 1
    buffer_atomic_add v34, off, s[24:27], 0 sc0
    s_mov_b64 exec, -1
    s_waitcnt vmcnt(0)
    v_readfirstlane_b32 s46, v34
    s_nop 0
    s_sub_u32 s48, s46, 0
    s_and_b32 s53, s48, 7
    s_lshl_b32 s53, s53, 20
    s_lshr_b32 s48, s48, 3
    s_mul_i32 s48, s48, 131072
    s_add_u32 s48, s48, s53
    s_add_u32 s48, s48, 0xc0000
    s_mov_b32 s49, 16
    s_mov_b32 s52, 8192
    s_cmp_lt_u32 s46, 8
    s_cbranch_scc1 L_mapped
    s_sub_u32 s48, s46, 8
    s_and_b32 s53, s48, 7
    s_lshl_b32 s53, s53, 20
    s_lshr_b32 s48, s48, 3
    s_mul_i32 s48, s48, 65536
    s_add_u32 s48, s48, s53
    s_add_u32 s48, s48, 0xe0001
    s_mov_b32 s49, 16
    s_mov_b32 s52, 4096
    s_cmp_lt_u32 s46, 16
    s_cbranch_scc1 L_mapped
    s_sub_u32 s48, s46, 16
    s_and_b32 s53, s48, 7
    s_lshl_b32 s53, s53, 20
    s_lshr_b32 s48, s48, 3
    s_mul_i32 s48, s48, 32768
    s_add_u32 s48, s48, s53
    s_add_u32 s48, s48, 0xf0001
    s_mov_b32 s49, 8
    s_mov_b32 s52, 4096
    s_cmp_lt_u32 s46, 24
    s_cbranch_scc1 L_mapped
    s_sub_u32 s48, s46, 24
    s_and_b32 s53, s48, 7
    s_lshl_b32 s53, s53, 20
    s_lshr_b32 s48, s48, 3
    s_mul_i32 s48, s48, 16384
    s_add_u32 s48, s48, s53
    s_add_u32 s48, s48, 0xf8001
    s_mov_b32 s49, 4
    s_mov_b32 s52, 4096
    s_cmp_lt_u32 s46, 40
    s_cbranch_scc1 L_mapped
    s_branch L_exh
L_mapped:
    v_mul_lo_u32 v37, s52, v0
    v_add_u32 v37, s48, v37
    v_add_u32 v36, s44, v0
    v_lshlrev_b32 v36, 2, v36
    v_cmp_gt_u32 vcc, s49, v0
    s_nop 0
    s_and_saveexec_b64 s[50:51], vcc
    ds_write_b32 v36, v37 offset:512
    s_mov_b64 exec, s[50:51]
    s_add_u32 s44, s44, s49
    s_add_u32 s45, s45, s49
    s_cmp_lt_u32 s44, 368
    s_cbranch_scc1 L_disp
L_exh:
    v_add_u32 v38, 0, v0
    v_lshlrev_b32 v36, 2, v38
    v_cmp_le_u32 vcc, s44, v38
    s_nop 0
    s_and_saveexec_b64 s[50:51], vcc
    s_cbranch_execz L_exh_sk0
    v_mov_b32 v37, 0x800000
    ds_write_b32 v36, v37 offset:512
L_exh_sk0:
    s_mov_b64 exec, s[50:51]
    v_add_u32 v38, 64, v0
    v_lshlrev_b32 v36, 2, v38
    v_cmp_le_u32 vcc, s44, v38
    s_nop 0
    s_and_saveexec_b64 s[50:51], vcc
    s_cbranch_execz L_exh_sk1
    v_mov_b32 v37, 0x800000
    ds_write_b32 v36, v37 offset:512
L_exh_sk1:
    s_mov_b64 exec, s[50:51]
    v_add_u32 v38, 128, v0
    v_lshlrev_b32 v36, 2, v38
    v_cmp_le_u32 vcc, s44, v38
    s_nop 0
    s_and_saveexec_b64 s[50:51], vcc
    s_cbranch_execz L_exh_sk2
    v_mov_b32 v37, 0x800000
    ds_write_b32 v36, v37 offset:512
L_exh_sk2:
    s_mov_b64 exec, s[50:51]
    v_add_u32 v38, 192, v0
    v_lshlrev_b32 v36, 2, v38
    v_cmp_le_u32 vcc, s44, v38
    s_nop 0
    s_and_saveexec_b64 s[50:51], vcc
    s_cbranch_execz L_exh_sk3
    v_mov_b32 v37, 0x800000
    ds_write_b32 v36, v37 offset:512
L_exh_sk3:
    s_mov_b64 exec, s[50:51]
    v_add_u32 v38, 256, v0
    v_lshlrev_b32 v36, 2, v38
    v_cmp_le_u32 vcc, s44, v38
    s_nop 0
    s_and_saveexec_b64 s[50:51], vcc
    s_cbranch_execz L_exh_sk4
    v_mov_b32 v37, 0x800000
    ds_write_b32 v36, v37 offset:512
L_exh_sk4:
    s_mov_b64 exec, s[50:51]
    v_add_u32 v38, 320, v0
    v_lshlrev_b32 v36, 2, v38
    v_cmp_le_u32 vcc, s44, v38
    s_nop 0
    s_and_saveexec_b64 s[50:51], vcc
    s_cbranch_execz L_exh_sk5
    v_mov_b32 v37, 0x800000
    ds_write_b32 v36, v37 offset:512
L_exh_sk5:
    s_mov_b64 exec, s[50:51]
    s_getpc_b64 s[24:25]
L_pc1:
    s_sub_u32 s24, s24, L_pc1-L_streamdone
    s_subb_u32 s25, s25, 0
    s_mov_b32 s26, L_helper-L_streamdone
    s_mov_b32 s27, 0x20000
    v_lshlrev_b32 v1, 4, v0
    s_mov_b32 s44, 0
    buffer_load_dwordx4 v[112:115], v1, s[24:27], s44 offen
    s_mov_b32 s44, 1024
    buffer_load_dwordx4 v[116:119], v1, s[24:27], s44 offen
    s_mov_b32 s44, 2048
    buffer_load_dwordx4 v[120:123], v1, s[24:27], s44 offen
    s_mov_b32 s44, 3072
    buffer_load_dwordx4 v[124:127], v1, s[24:27], s44 offen
    s_mov_b32 s44, 4096
    buffer_load_dwordx4 v[112:115], v1, s[24:27], s44 offen
    s_mov_b32 s44, 5120
    buffer_load_dwordx4 v[116:119], v1, s[24:27], s44 offen
    s_mov_b32 s44, 6144
    buffer_load_dwordx4 v[120:123], v1, s[24:27], s44 offen
    s_waitcnt vmcnt(0) lgkmcnt(0)
L_done:
    s_endpgm
KEND:
.section .rodata,"a"
.p2align 6
.amdhsa_kernel sequential_preLN__gqa_block_cached__glu_gated_bilinear__decode_kernel
  .amdhsa_next_free_vgpr 144
  .amdhsa_next_free_sgpr 96
  .amdhsa_accum_offset 144
  .amdhsa_group_segment_fixed_size 0
  .amdhsa_kernarg_size 96
  .amdhsa_user_sgpr_count 2
  .amdhsa_user_sgpr_kernarg_segment_ptr 1
  .amdhsa_system_sgpr_workgroup_id_x 1
.end_amdhsa_kernel
```
